```python
import torch

def _softmax(x, axis=-1):
    return torch.softmax(x, dim=axis)
def _gelu(x):
    return torch.nn.functional.gelu(x, approximate="tanh")
def _silu(x):
    return torch.nn.functional.silu(x)
def _sigmoid(x):
    return torch.sigmoid(x)
def _layernorm(x, axis=-1, eps=1e-5):
    m = x.mean(dim=axis, keepdim=True)
    v = x.var(dim=axis, keepdim=True, unbiased=False)
    return (x - m) / torch.sqrt(v + eps)
def _scatter_add(tgt, idx, src, axis=0):
    return tgt.clone().index_add_(axis, idx, src)
def _segment_sum(src, seg, n):
    out = torch.zeros((n,) + src.shape[1:], dtype=src.dtype)
    return out.index_add_(0, seg, src)
def _pad(x, pw):
    flat = tuple(v for pair in reversed(pw) for v in pair)
    return torch.nn.functional.pad(x, flat)

kernel_name = 'standalone__glu_gated_glu__prompt'

def setup_inputs():

    _w = (lambda a: (lambda t: t.to(torch.bfloat16) if t.is_floating_point() else t)(torch.as_tensor(a)))
    B, S, D, F = 1, 2048, 640, 1536
    return {
        "x": _w((lambda *s: torch.randn(*s, dtype=torch.bfloat16) * 0.2)(B, S, D)),
        "w_gate": _w((lambda *s: torch.randn(*s, dtype=torch.bfloat16) * 0.2)(D, F)),
        "w_up": _w((lambda *s: torch.randn(*s, dtype=torch.bfloat16) * 0.05)(D, F)),
        "w_down": _w((lambda *s: torch.randn(*s, dtype=torch.bfloat16) * 0.05)(F, D)),
    }

def reference(x, w_gate, w_up, w_down):
    g = torch.einsum("bsd,df->bsf", x, w_gate)
    u = torch.einsum("bsd,df->bsf", x, w_up)
    h = _sigmoid(g) * u
    return torch.einsum("bsf,fd->bsd", h, w_down)
```

```asm
; @launch grid=(256,1,1) block=(512,1,1) lds=163840
.amdgcn_target "amdgcn-amd-amdhsa--gfx950"
.text
.globl standalone__glu_gated_glu__prompt_kernel
.p2align 8
.type standalone__glu_gated_glu__prompt_kernel,@function
standalone__glu_gated_glu__prompt_kernel:
    s_cmp_ge_u32 s2, 256
    s_cbranch_scc1 L_end_standa
    s_load_dwordx4 s[4:7], s[0:1], 0
    s_load_dwordx4 s[8:11], s[0:1], 16
    s_load_dwordx4 s[12:15], s[0:1], 32
    s_load_dwordx2 s[46:47], s[0:1], 48
    v_lshrrev_b32 v1, 6, v0
    v_and_b32 v2, 63, v0
    v_readfirstlane_b32 s19, v1
    s_and_b32 s48, s2, 7
    s_lshr_b32 s49, s2, 3
    s_and_b32 s16, s48, 1
    s_lshl_b32 s16, s16, 3
    s_and_b32 s17, s49, 7
    s_add_u32 s16, s16, s17
    s_lshr_b32 s17, s48, 1
    s_lshl_b32 s17, s17, 2
    s_lshr_b32 s18, s49, 3
    s_add_u32 s17, s17, s18
    s_cmp_lt_u32 s19, 4
    s_cbranch_scc1 L_comp_standa
    s_sub_u32 s19, s19, 4
    v_lshrrev_b32 v3, 3, v2
    v_and_b32 v4, 7, v2
    v_lshrrev_b32 v5, 1, v3
    s_lshl_b32 s32, s16, 7
    s_lshl_b32 s33, s19, 5
    s_add_u32 s32, s32, s33
    v_add_u32 v3, s32, v3
    v_mul_u32_u24 v3, 1280, v3
    v_xor_b32 v6, v4, v5
    v_xor_b32 v7, 4, v6
    v_lshl_add_u32 v140, v6, 4, v3
    v_lshl_add_u32 v141, v7, 4, v3
    v_add_u32 v142, 18432, v140
    v_add_u32 v143, 27648, v141
    v_add_u32 v141, 9216, v141
    s_mul_i32 s35, s17, 192
    s_mul_i32 s36, s19, 192
    s_add_u32 s37, s36, 0
    v_add_u32 v5, s37, v2
    v_mul_u32_u24 v6, 43691, v5
    v_lshrrev_b32 v6, 19, v6
    v_mul_u32_u24 v7, 12, v6
    v_sub_u32 v7, v5, v7
    v_bfe_u32 v5, v6, 3, 1
    v_lshlrev_b32 v5, 1, v5
    v_xor_b32 v7, v7, v5
    v_mul_u32_u24 v6, 3072, v6
    s_mov_b32 s37, s35
    v_add_u32 v6, s37, v6
    v_lshl_add_u32 v144, v7, 4, v6
    s_add_u32 s37, s36, 64
    v_add_u32 v5, s37, v2
    v_mul_u32_u24 v6, 43691, v5
    v_lshrrev_b32 v6, 19, v6
    v_mul_u32_u24 v7, 12, v6
    v_sub_u32 v7, v5, v7
    v_bfe_u32 v5, v6, 3, 1
    v_lshlrev_b32 v5, 1, v5
    v_xor_b32 v7, v7, v5
    v_mul_u32_u24 v6, 3072, v6
    s_sub_u32 s37, s35, 1024
    v_add_u32 v6, s37, v6
    v_lshl_add_u32 v145, v7, 4, v6
    s_add_u32 s37, s36, 128
    v_add_u32 v5, s37, v2
    v_mul_u32_u24 v6, 43691, v5
    v_lshrrev_b32 v6, 19, v6
    v_mul_u32_u24 v7, 12, v6
    v_sub_u32 v7, v5, v7
    v_bfe_u32 v5, v6, 3, 1
    v_lshlrev_b32 v5, 1, v5
    v_xor_b32 v7, v7, v5
    v_mul_u32_u24 v6, 3072, v6
    s_sub_u32 s37, s35, 2048
    v_add_u32 v6, s37, v6
    v_lshl_add_u32 v146, v7, 4, v6
    s_lshl_b32 s37, s19, 12
    s_mul_i32 s38, s19, 3072
    s_add_u32 s38, s38, 16384
    s_add_u32 s39, s38, 12288
    s_add_u32 s43, s16, s17
    s_and_b32 s43, s43, 3
    s_mov_b32 s60, 0x76453201
    s_mov_b32 s61, 0x89
    s_cmp_eq_u32 s43, 1
    s_cselect_b32 s60, 0x75643120, s60
    s_cselect_b32 s61, 0x98, s61
    s_cmp_eq_u32 s43, 2
    s_cselect_b32 s60, 0x67542310, s60
    s_cselect_b32 s61, 0x98, s61
    s_cmp_eq_u32 s43, 3
    s_cselect_b32 s60, 0x86534210, s60
    s_cselect_b32 s61, 0x97, s61
    s_mov_b32 s42, 0
    s_waitcnt lgkmcnt(0)
    s_mov_b32 s20, s4
    s_and_b32 s21, s5, 0xffff
    s_mov_b32 s22, 2621440
    s_mov_b32 s23, 0x20000
    s_mov_b32 s24, s6
    s_and_b32 s25, s7, 0xffff
    s_mov_b32 s26, 1966080
    s_mov_b32 s27, 0x20000
    s_mov_b32 s28, s8
    s_and_b32 s29, s9, 0xffff
    s_mov_b32 s30, 1966080
    s_mov_b32 s31, 0x20000
    s_and_b32 s40, s60, 15
    s_lshr_b64 s[60:61], s[60:61], 4
    s_mul_i32 s41, s40, 196608
    s_lshl_b32 s40, s40, 7
    s_add_u32 m0, s42, s37
    s_add_u32 s43, s42, s38
    buffer_load_dwordx4 v140, s[20:23], s40 offen offset:0 lds
    buffer_load_dwordx4 v141, s[20:23], s40 offen offset:1024 lds
    buffer_load_dwordx4 v142, s[20:23], s40 offen offset:2048 lds
    buffer_load_dwordx4 v143, s[20:23], s40 offen offset:3072 lds
    s_mov_b32 m0, s43
    s_add_u32 s43, s42, s39
    buffer_load_dwordx4 v144, s[24:27], s41 offen offset:0 lds
    buffer_load_dwordx4 v145, s[24:27], s41 offen offset:1024 lds
    buffer_load_dwordx4 v146, s[24:27], s41 offen offset:2048 lds
    s_mov_b32 m0, s43
    s_add_u32 s42, s42, 40960
    buffer_load_dwordx4 v144, s[28:31], s41 offen offset:0 lds
    buffer_load_dwordx4 v145, s[28:31], s41 offen offset:1024 lds
    buffer_load_dwordx4 v146, s[28:31], s41 offen offset:2048 lds
    s_cmp_eq_u32 s42, 122880
    s_cselect_b32 s42, 0, s42
    s_lshl_b32 s50, s48, 2
    s_and_b32 s51, s49, 3
    s_add_u32 s50, s50, s51
    s_lshr_b32 s51, s49, 2
    s_mul_i32 s43, s51, 5
    s_lshr_b32 s43, s43, 2
    s_lshl_b32 s43, s43, 2
    s_add_u32 s43, s43, s19
    s_lshl_b32 s43, s43, 7
    s_add_u32 s43, s43, 12648448
    v_and_b32 v4, 7, v2
    v_lshlrev_b32 v4, 3, v4
    v_bfe_u32 v5, v2, 3, 1
    v_lshl_add_u32 v4, v5, 9, v4
    v_add_u32 v4, s43, v4
    v_lshlrev_b32 v3, 4, v2
    s_mul_i32 s32, s19, 12
    s_mul_i32 s33, s51, 48
    s_add_u32 s33, s33, s32
    s_mul_i32 s33, s33, 5120
    s_mul_i32 s35, s50, 48
    s_add_u32 s35, s35, s32
    s_lshl_b32 s35, s35, 12
    s_mul_i32 s36, s19, 10240
    s_add_u32 s43, s50, s51
    s_and_b32 s43, s43, 3
    s_mov_b32 s45, 0x453201
    s_cmp_eq_u32 s43, 1
    s_cselect_b32 s45, 0x543120, s45
    s_cmp_eq_u32 s43, 2
    s_cselect_b32 s45, 0x542310, s45
    s_cmp_eq_u32 s43, 3
    s_cselect_b32 s45, 0x534210, s45
    s_bfe_u32 s43, s45, 0x40000
    s_mul_i32 s4, s43, 10240
    s_add_u32 s4, s4, s33
    s_lshl_b32 s43, s43, 13
    s_add_u32 s52, s43, s35
    s_bfe_u32 s43, s45, 0x40004
    s_mul_i32 s5, s43, 10240
    s_add_u32 s5, s5, s33
    s_lshl_b32 s43, s43, 13
    s_add_u32 s53, s43, s35
    s_bfe_u32 s43, s45, 0x40008
    s_mul_i32 s6, s43, 10240
    s_add_u32 s6, s6, s33
    s_lshl_b32 s43, s43, 13
    s_add_u32 s54, s43, s35
    s_bfe_u32 s43, s45, 0x4000c
    s_mul_i32 s7, s43, 10240
    s_add_u32 s7, s7, s33
    s_lshl_b32 s43, s43, 13
    s_add_u32 s55, s43, s35
    s_bfe_u32 s43, s45, 0x40010
    s_mul_i32 s8, s43, 10240
    s_add_u32 s8, s8, s33
    s_lshl_b32 s43, s43, 13
    s_add_u32 s56, s43, s35
    s_bfe_u32 s43, s45, 0x40014
    s_mul_i32 s9, s43, 10240
    s_add_u32 s9, s9, s33
    s_lshl_b32 s43, s43, 13
    s_add_u32 s57, s43, s35
    s_add_u32 s64, s46, 8388608
    s_addc_u32 s65, s47, 0
    s_and_b32 s65, s65, 0xffff
    s_mov_b32 s66, 1966080
    s_mov_b32 s67, 0x20000
    s_mov_b32 s68, s46
    s_and_b32 s69, s47, 0xffff
    s_mov_b32 s70, 6291456
    s_mov_b32 s71, 0x20000
    s_mov_b32 s72, s12
    s_and_b32 s73, s13, 0xffff
    s_mov_b32 s74, 2621440
    s_mov_b32 s75, 0x20000
    s_add_u32 s43, s19, 0
    s_and_b32 s43, s43, 3
    s_lshl_b32 s43, s43, 10
    v_add_u32 v232, s43, v3
    s_add_u32 s43, s19, 1
    s_and_b32 s43, s43, 3
    s_lshl_b32 s43, s43, 10
    v_add_u32 v233, s43, v3
    s_add_u32 s43, s19, 2
    s_and_b32 s43, s43, 3
    s_lshl_b32 s43, s43, 10
    v_add_u32 v234, s43, v3
    s_add_u32 s43, s19, 3
    s_and_b32 s43, s43, 3
    s_lshl_b32 s43, s43, 10
    v_add_u32 v235, s43, v3
    s_lshr_b32 s43, s50, 1
    s_lshl_b32 s43, s43, 2
    s_add_u32 s43, s43, s19
    s_lshl_b32 s43, s43, 9
    s_and_b32 s45, s50, 1
    s_lshl_b32 s45, s45, 4
    s_add_u32 s43, s43, s45
    s_add_u32 s43, s43, 12582912
    v_and_b32 v5, 3, v2
    v_lshlrev_b32 v5, 7, v5
    v_add_u32 v237, s43, v5
    s_add_u32 s43, s36, 81920
    v_add_u32 v236, s43, v3
    s_mov_b32 s44, 1
L_ld_standa:
    s_and_b32 s40, s60, 15
    s_lshr_b64 s[60:61], s[60:61], 4
    s_mul_i32 s41, s40, 196608
    s_lshl_b32 s40, s40, 7
    s_add_u32 m0, s42, s37
    s_add_u32 s43, s42, s38
    buffer_load_dwordx4 v140, s[20:23], s40 offen offset:0 lds
    buffer_load_dwordx4 v141, s[20:23], s40 offen offset:1024 lds
    buffer_load_dwordx4 v142, s[20:23], s40 offen offset:2048 lds
    buffer_load_dwordx4 v143, s[20:23], s40 offen offset:3072 lds
    s_mov_b32 m0, s43
    s_add_u32 s43, s42, s39
    buffer_load_dwordx4 v144, s[24:27], s41 offen offset:0 lds
    buffer_load_dwordx4 v145, s[24:27], s41 offen offset:1024 lds
    buffer_load_dwordx4 v146, s[24:27], s41 offen offset:2048 lds
    s_mov_b32 m0, s43
    s_add_u32 s42, s42, 40960
    buffer_load_dwordx4 v144, s[28:31], s41 offen offset:0 lds
    buffer_load_dwordx4 v145, s[28:31], s41 offen offset:1024 lds
    buffer_load_dwordx4 v146, s[28:31], s41 offen offset:2048 lds
    s_cmp_eq_u32 s42, 122880
    s_cselect_b32 s42, 0, s42
    s_waitcnt vmcnt(10)
    s_barrier
    s_add_u32 s44, s44, 1
    s_cmp_lt_u32 s44, 9
    s_cbranch_scc1 L_ld_standa
    v_mov_b32 v5, 131072
    ds_read_b64 v[238:239], v5
    s_mov_b64 exec, 0x3f3f
    global_load_dwordx2 v[138:139], v4, s[46:47] sc1
    s_mov_b64 exec, -1
    s_and_b32 s40, s60, 15
    s_lshr_b64 s[60:61], s[60:61], 4
    s_mul_i32 s41, s40, 196608
    s_lshl_b32 s40, s40, 7
    s_add_u32 m0, s42, s37
    s_add_u32 s43, s42, s38
    buffer_load_dwordx4 v140, s[20:23], s40 offen offset:0 lds
    buffer_load_dwordx4 v141, s[20:23], s40 offen offset:1024 lds
    buffer_load_dwordx4 v142, s[20:23], s40 offen offset:2048 lds
    buffer_load_dwordx4 v143, s[20:23], s40 offen offset:3072 lds
    s_mov_b32 m0, s43
    s_add_u32 s43, s42, s39
    buffer_load_dwordx4 v144, s[24:27], s41 offen offset:0 lds
    buffer_load_dwordx4 v145, s[24:27], s41 offen offset:1024 lds
    buffer_load_dwordx4 v146, s[24:27], s41 offen offset:2048 lds
    s_mov_b32 m0, s43
    s_add_u32 s42, s42, 40960
    buffer_load_dwordx4 v144, s[28:31], s41 offen offset:0 lds
    buffer_load_dwordx4 v145, s[28:31], s41 offen offset:1024 lds
    buffer_load_dwordx4 v146, s[28:31], s41 offen offset:2048 lds
    s_cmp_eq_u32 s42, 122880
    s_cselect_b32 s42, 0, s42
    s_waitcnt vmcnt(11) lgkmcnt(0)
    s_barrier
    s_waitcnt vmcnt(10)
    s_mov_b64 exec, 0x3f3f
    s_mov_b32 s44, 0
L_pk_standa:
    v_cmp_ne_u64 vcc, v[138:139], v[238:239]
    s_cbranch_vccz L_pk_ok_standa
    s_sleep 4
    global_load_dwordx2 v[138:139], v4, s[46:47] sc1
    s_waitcnt vmcnt(0)
    s_add_u32 s44, s44, 1
    s_cmp_lt_u32 s44, 0x80000
    s_cbranch_scc1 L_pk_standa
L_pk_ok_standa:
    s_mov_b64 exec, -1
    s_add_u32 s43, s4, 0
    buffer_load_dwordx4 v[8:11], v3, s[64:67], s43 offen offset:0 sc1
    buffer_load_dwordx4 v[12:15], v3, s[64:67], s43 offen offset:1024 sc1
    buffer_load_dwordx4 v[16:19], v3, s[64:67], s43 offen offset:2048 sc1
    buffer_load_dwordx4 v[20:23], v3, s[64:67], s43 offen offset:3072 sc1
    s_add_u32 s43, s4, 4096
    buffer_load_dwordx4 v[24:27], v3, s[64:67], s43 offen offset:0 sc1
    buffer_load_dwordx4 v[28:31], v3, s[64:67], s43 offen offset:1024 sc1
    buffer_load_dwordx4 v[32:35], v3, s[64:67], s43 offen offset:2048 sc1
    buffer_load_dwordx4 v[36:39], v3, s[64:67], s43 offen offset:3072 sc1
    s_add_u32 s43, s4, 8192
    buffer_load_dwordx4 v[40:43], v3, s[64:67], s43 offen offset:0 sc1
    buffer_load_dwordx4 v[44:47], v3, s[64:67], s43 offen offset:1024 sc1
    s_waitcnt vmcnt(10)
    s_barrier
    s_add_u32 s43, s5, 0
    buffer_load_dwordx4 v[48:51], v3, s[64:67], s43 offen offset:0 sc1
    buffer_load_dwordx4 v[52:55], v3, s[64:67], s43 offen offset:1024 sc1
    buffer_load_dwordx4 v[56:59], v3, s[64:67], s43 offen offset:2048 sc1
    buffer_load_dwordx4 v[60:63], v3, s[64:67], s43 offen offset:3072 sc1
    s_add_u32 s43, s5, 4096
    buffer_load_dwordx4 v[64:67], v3, s[64:67], s43 offen offset:0 sc1
    buffer_load_dwordx4 v[68:71], v3, s[64:67], s43 offen offset:1024 sc1
    buffer_load_dwordx4 v[72:75], v3, s[64:67], s43 offen offset:2048 sc1
    buffer_load_dwordx4 v[76:79], v3, s[64:67], s43 offen offset:3072 sc1
    s_add_u32 s43, s5, 8192
    buffer_load_dwordx4 v[80:83], v3, s[64:67], s43 offen offset:0 sc1
    buffer_load_dwordx4 v[84:87], v3, s[64:67], s43 offen offset:1024 sc1
    s_barrier
    s_add_u32 m0, s36, 81920
    s_add_u32 s43, s6, 0
    buffer_load_dwordx4 v3, s[64:67], s43 offen offset:0 sc1 lds
    buffer_load_dwordx4 v3, s[64:67], s43 offen offset:1024 sc1 lds
    buffer_load_dwordx4 v3, s[64:67], s43 offen offset:2048 sc1 lds
    buffer_load_dwordx4 v3, s[64:67], s43 offen offset:3072 sc1 lds
    s_add_u32 m0, s36, 86016
    s_add_u32 s43, s6, 4096
    buffer_load_dwordx4 v3, s[64:67], s43 offen offset:0 sc1 lds
    buffer_load_dwordx4 v3, s[64:67], s43 offen offset:1024 sc1 lds
    buffer_load_dwordx4 v3, s[64:67], s43 offen offset:2048 sc1 lds
    buffer_load_dwordx4 v3, s[64:67], s43 offen offset:3072 sc1 lds
    s_add_u32 m0, s36, 90112
    s_add_u32 s43, s6, 8192
    buffer_load_dwordx4 v3, s[64:67], s43 offen offset:0 sc1 lds
    buffer_load_dwordx4 v3, s[64:67], s43 offen offset:1024 sc1 lds
    s_barrier
    s_add_u32 m0, s36, 122880
    s_add_u32 s43, s7, 0
    buffer_load_dwordx4 v3, s[64:67], s43 offen offset:0 sc1 lds
    buffer_load_dwordx4 v3, s[64:67], s43 offen offset:1024 sc1 lds
    buffer_load_dwordx4 v3, s[64:67], s43 offen offset:2048 sc1 lds
    buffer_load_dwordx4 v3, s[64:67], s43 offen offset:3072 sc1 lds
    s_add_u32 m0, s36, 126976
    s_add_u32 s43, s7, 4096
    buffer_load_dwordx4 v3, s[64:67], s43 offen offset:0 sc1 lds
    buffer_load_dwordx4 v3, s[64:67], s43 offen offset:1024 sc1 lds
    buffer_load_dwordx4 v3, s[64:67], s43 offen offset:2048 sc1 lds
    buffer_load_dwordx4 v3, s[64:67], s43 offen offset:3072 sc1 lds
    s_add_u32 m0, s36, 131072
    s_add_u32 s43, s7, 8192
    buffer_load_dwordx4 v3, s[64:67], s43 offen offset:0 sc1 lds
    buffer_load_dwordx4 v3, s[64:67], s43 offen offset:1024 sc1 lds
    s_add_u32 m0, s36, 0
    s_add_u32 s43, s8, 0
    buffer_load_dwordx4 v3, s[64:67], s43 offen offset:0 sc1 lds
    buffer_load_dwordx4 v3, s[64:67], s43 offen offset:1024 sc1 lds
    buffer_load_dwordx4 v3, s[64:67], s43 offen offset:2048 sc1 lds
    buffer_load_dwordx4 v3, s[64:67], s43 offen offset:3072 sc1 lds
    s_add_u32 m0, s36, 4096
    s_add_u32 s43, s8, 4096
    buffer_load_dwordx4 v3, s[64:67], s43 offen offset:0 sc1 lds
    buffer_load_dwordx4 v3, s[64:67], s43 offen offset:1024 sc1 lds
    buffer_load_dwordx4 v3, s[64:67], s43 offen offset:2048 sc1 lds
    buffer_load_dwordx4 v3, s[64:67], s43 offen offset:3072 sc1 lds
    s_add_u32 m0, s36, 8192
    s_add_u32 s43, s8, 8192
    buffer_load_dwordx4 v3, s[64:67], s43 offen offset:0 sc1 lds
    buffer_load_dwordx4 v3, s[64:67], s43 offen offset:1024 sc1 lds
    s_add_u32 m0, s36, 40960
    s_add_u32 s43, s9, 0
    buffer_load_dwordx4 v3, s[64:67], s43 offen offset:0 sc1 lds
    buffer_load_dwordx4 v3, s[64:67], s43 offen offset:1024 sc1 lds
    buffer_load_dwordx4 v3, s[64:67], s43 offen offset:2048 sc1 lds
    buffer_load_dwordx4 v3, s[64:67], s43 offen offset:3072 sc1 lds
    s_add_u32 m0, s36, 45056
    s_add_u32 s43, s9, 4096
    buffer_load_dwordx4 v3, s[64:67], s43 offen offset:0 sc1 lds
    buffer_load_dwordx4 v3, s[64:67], s43 offen offset:1024 sc1 lds
    s_mov_b64 exec, 0xf
    global_load_dwordx4 v[4:7], v237, s[46:47] sc1
    s_mov_b64 exec, -1
    s_add_u32 m0, s36, 45056
    s_add_u32 s43, s9, 4096
    buffer_load_dwordx4 v3, s[64:67], s43 offen offset:2048 sc1 lds
    buffer_load_dwordx4 v3, s[64:67], s43 offen offset:3072 sc1 lds
    s_add_u32 m0, s36, 49152
    s_add_u32 s43, s9, 8192
    buffer_load_dwordx4 v3, s[64:67], s43 offen offset:0 sc1 lds
    buffer_load_dwordx4 v3, s[64:67], s43 offen offset:1024 sc1 lds
    s_waitcnt vmcnt(4)
    s_mov_b64 exec, 0xf
L_poll_standa:
    v_cmp_ne_u64 vcc, v[4:5], v[238:239]
    v_cmp_ne_u64 s[58:59], v[6:7], v[238:239]
    s_nop 0
    s_or_b64 vcc, vcc, s[58:59]
    s_cbranch_vccz L_go_standa
    global_load_dwordx4 v[240:243], v237, s[46:47] sc1
L_poll2_standa:
    s_sleep 2
    global_load_dwordx4 v[4:7], v237, s[46:47] sc1
    s_waitcnt vmcnt(1)
    v_cmp_ne_u64 vcc, v[240:241], v[238:239]
    v_cmp_ne_u64 s[58:59], v[242:243], v[238:239]
    s_nop 0
    s_or_b64 vcc, vcc, s[58:59]
    s_cbranch_vccz L_go1_standa
    s_sleep 2
    global_load_dwordx4 v[240:243], v237, s[46:47] sc1
    s_waitcnt vmcnt(1)
    v_cmp_ne_u64 vcc, v[4:5], v[238:239]
    v_cmp_ne_u64 s[58:59], v[6:7], v[238:239]
    s_nop 0
    s_or_b64 vcc, vcc, s[58:59]
    s_cbranch_vccz L_go1_standa
    s_add_u32 s44, s44, 1
    s_cmp_lt_u32 s44, 0x80000
    s_cbranch_scc1 L_poll2_standa
L_go1_standa:
L_go_standa:
    s_mov_b64 exec, -1
    v_add_u32 v1, s36, v3
    s_add_u32 s20, s52, 4096
    s_add_u32 s21, s53, 4096
    s_add_u32 s22, s54, 4096
    s_add_u32 s23, s55, 4096
    s_add_u32 s24, s56, 4096
    s_add_u32 s25, s57, 4096
    buffer_load_dwordx4 v[88:91], v232, s[68:71], s52 offen sc1
    buffer_load_dwordx4 v[92:95], v233, s[68:71], s52 offen sc1
    buffer_load_dwordx4 v[96:99], v234, s[68:71], s52 offen sc1
    buffer_load_dwordx4 v[100:103], v235, s[68:71], s52 offen sc1
    buffer_load_dwordx4 v[104:107], v232, s[68:71], s20 offen sc1
    buffer_load_dwordx4 v[108:111], v233, s[68:71], s20 offen sc1
    buffer_load_dwordx4 v[112:115], v234, s[68:71], s20 offen sc1
    buffer_load_dwordx4 v[116:119], v235, s[68:71], s20 offen sc1
    s_waitcnt vmcnt(7)
    v_mfma_f32_16x16x32_bf16 v[152:155], v[8:11], v[88:91], 0
    buffer_load_dwordx4 v[120:123], v232, s[68:71], s53 offen sc1
    v_mfma_f32_16x16x32_bf16 v[168:171], v[12:15], v[88:91], 0
    v_mfma_f32_16x16x32_bf16 v[184:187], v[16:19], v[88:91], 0
    buffer_load_dwordx4 v[124:127], v233, s[68:71], s53 offen sc1
    v_mfma_f32_16x16x32_bf16 v[200:203], v[20:23], v[88:91], 0
    v_mfma_f32_16x16x32_bf16 v[216:219], v[24:27], v[88:91], 0
    s_waitcnt vmcnt(8)
    v_mfma_f32_16x16x32_bf16 v[156:159], v[8:11], v[92:95], 0
    buffer_load_dwordx4 v[128:131], v234, s[68:71], s53 offen sc1
    v_mfma_f32_16x16x32_bf16 v[172:175], v[12:15], v[92:95], 0
    v_mfma_f32_16x16x32_bf16 v[188:191], v[16:19], v[92:95], 0
    buffer_load_dwordx4 v[132:135], v235, s[68:71], s53 offen sc1
    v_mfma_f32_16x16x32_bf16 v[204:207], v[20:23], v[92:95], 0
    v_mfma_f32_16x16x32_bf16 v[220:223], v[24:27], v[92:95], 0
    s_waitcnt vmcnt(9)
    v_mfma_f32_16x16x32_bf16 v[160:163], v[8:11], v[96:99], 0
    buffer_load_dwordx4 v[136:139], v232, s[68:71], s21 offen sc1
    v_mfma_f32_16x16x32_bf16 v[176:179], v[12:15], v[96:99], 0
    v_mfma_f32_16x16x32_bf16 v[192:195], v[16:19], v[96:99], 0
    buffer_load_dwordx4 v[140:143], v233, s[68:71], s21 offen sc1
    v_mfma_f32_16x16x32_bf16 v[208:211], v[20:23], v[96:99], 0
    v_mfma_f32_16x16x32_bf16 v[224:227], v[24:27], v[96:99], 0
    s_waitcnt vmcnt(10)
    v_mfma_f32_16x16x32_bf16 v[164:167], v[8:11], v[100:103], 0
    buffer_load_dwordx4 v[144:147], v234, s[68:71], s21 offen sc1
    v_mfma_f32_16x16x32_bf16 v[180:183], v[12:15], v[100:103], 0
    v_mfma_f32_16x16x32_bf16 v[196:199], v[16:19], v[100:103], 0
    buffer_load_dwordx4 v[148:151], v235, s[68:71], s21 offen sc1
    v_mfma_f32_16x16x32_bf16 v[212:215], v[20:23], v[100:103], 0
    v_mfma_f32_16x16x32_bf16 v[228:231], v[24:27], v[100:103], 0
    s_waitcnt vmcnt(11)
    v_mfma_f32_16x16x32_bf16 v[152:155], v[28:31], v[104:107], v[152:155]
    buffer_load_dwordx4 v[244:247], v232, s[68:71], s54 offen sc1
    ds_read_b128 v[8:11], v236 offset:0
    v_mfma_f32_16x16x32_bf16 v[168:171], v[32:35], v[104:107], v[168:171]
    ds_read_b128 v[12:15], v236 offset:1024
    v_mfma_f32_16x16x32_bf16 v[184:187], v[36:39], v[104:107], v[184:187]
    buffer_load_dwordx4 v[88:91], v233, s[68:71], s54 offen sc1
    ds_read_b128 v[16:19], v236 offset:2048
    v_mfma_f32_16x16x32_bf16 v[200:203], v[40:43], v[104:107], v[200:203]
    ds_read_b128 v[20:23], v236 offset:3072
    v_mfma_f32_16x16x32_bf16 v[216:219], v[44:47], v[104:107], v[216:219]
    ds_read_b128 v[24:27], v236 offset:4096
    s_waitcnt vmcnt(12)
    v_mfma_f32_16x16x32_bf16 v[156:159], v[28:31], v[108:111], v[156:159]
    buffer_load_dwordx4 v[92:95], v234, s[68:71], s54 offen sc1
    v_mfma_f32_16x16x32_bf16 v[172:175], v[32:35], v[108:111], v[172:175]
    v_mfma_f32_16x16x32_bf16 v[188:191], v[36:39], v[108:111], v[188:191]
    buffer_load_dwordx4 v[96:99], v235, s[68:71], s54 offen sc1
    v_mfma_f32_16x16x32_bf16 v[204:207], v[40:43], v[108:111], v[204:207]
    v_mfma_f32_16x16x32_bf16 v[220:223], v[44:47], v[108:111], v[220:223]
    s_waitcnt vmcnt(13)
    v_mfma_f32_16x16x32_bf16 v[160:163], v[28:31], v[112:115], v[160:163]
    buffer_load_dwordx4 v[100:103], v232, s[68:71], s22 offen sc1
    v_mfma_f32_16x16x32_bf16 v[176:179], v[32:35], v[112:115], v[176:179]
    v_mfma_f32_16x16x32_bf16 v[192:195], v[36:39], v[112:115], v[192:195]
    buffer_load_dwordx4 v[104:107], v233, s[68:71], s22 offen sc1
    v_mfma_f32_16x16x32_bf16 v[208:211], v[40:43], v[112:115], v[208:211]
    v_mfma_f32_16x16x32_bf16 v[224:227], v[44:47], v[112:115], v[224:227]
    s_waitcnt vmcnt(14)
    v_mfma_f32_16x16x32_bf16 v[164:167], v[28:31], v[116:119], v[164:167]
    buffer_load_dwordx4 v[108:111], v234, s[68:71], s22 offen sc1
    v_mfma_f32_16x16x32_bf16 v[180:183], v[32:35], v[116:119], v[180:183]
    v_mfma_f32_16x16x32_bf16 v[196:199], v[36:39], v[116:119], v[196:199]
    buffer_load_dwordx4 v[112:115], v235, s[68:71], s22 offen sc1
    v_mfma_f32_16x16x32_bf16 v[212:215], v[40:43], v[116:119], v[212:215]
    v_mfma_f32_16x16x32_bf16 v[228:231], v[44:47], v[116:119], v[228:231]
    s_waitcnt vmcnt(15)
    v_mfma_f32_16x16x32_bf16 v[152:155], v[48:51], v[120:123], v[152:155]
    buffer_load_dwordx4 v[116:119], v232, s[68:71], s55 offen sc1
    ds_read_b128 v[28:31], v236 offset:5120
    v_mfma_f32_16x16x32_bf16 v[168:171], v[52:55], v[120:123], v[168:171]
    ds_read_b128 v[32:35], v236 offset:6144
    v_mfma_f32_16x16x32_bf16 v[184:187], v[56:59], v[120:123], v[184:187]
    ds_read_b128 v[36:39], v236 offset:7168
    v_mfma_f32_16x16x32_bf16 v[200:203], v[60:63], v[120:123], v[200:203]
    ds_read_b128 v[40:43], v236 offset:8192
    v_mfma_f32_16x16x32_bf16 v[216:219], v[64:67], v[120:123], v[216:219]
    ds_read_b128 v[44:47], v236 offset:9216
    s_waitcnt vmcnt(15)
    v_mfma_f32_16x16x32_bf16 v[156:159], v[48:51], v[124:127], v[156:159]
    buffer_load_dwordx4 v[120:123], v233, s[68:71], s55 offen sc1
    v_mfma_f32_16x16x32_bf16 v[172:175], v[52:55], v[124:127], v[172:175]
    v_mfma_f32_16x16x32_bf16 v[188:191], v[56:59], v[124:127], v[188:191]
    v_mfma_f32_16x16x32_bf16 v[204:207], v[60:63], v[124:127], v[204:207]
    v_mfma_f32_16x16x32_bf16 v[220:223], v[64:67], v[124:127], v[220:223]
    s_waitcnt vmcnt(15)
    v_mfma_f32_16x16x32_bf16 v[160:163], v[48:51], v[128:131], v[160:163]
    buffer_load_dwordx4 v[124:127], v234, s[68:71], s55 offen sc1
    v_mfma_f32_16x16x32_bf16 v[176:179], v[52:55], v[128:131], v[176:179]
    v_mfma_f32_16x16x32_bf16 v[192:195], v[56:59], v[128:131], v[192:195]
    v_mfma_f32_16x16x32_bf16 v[208:211], v[60:63], v[128:131], v[208:211]
    v_mfma_f32_16x16x32_bf16 v[224:227], v[64:67], v[128:131], v[224:227]
    s_waitcnt vmcnt(15)
    v_mfma_f32_16x16x32_bf16 v[164:167], v[48:51], v[132:135], v[164:167]
    buffer_load_dwordx4 v[128:131], v235, s[68:71], s55 offen sc1
    v_mfma_f32_16x16x32_bf16 v[180:183], v[52:55], v[132:135], v[180:183]
    v_mfma_f32_16x16x32_bf16 v[196:199], v[56:59], v[132:135], v[196:199]
    v_mfma_f32_16x16x32_bf16 v[212:215], v[60:63], v[132:135], v[212:215]
    v_mfma_f32_16x16x32_bf16 v[228:231], v[64:67], v[132:135], v[228:231]
    s_waitcnt vmcnt(15)
    v_mfma_f32_16x16x32_bf16 v[152:155], v[68:71], v[136:139], v[152:155]
    buffer_load_dwordx4 v[132:135], v232, s[68:71], s23 offen sc1
    ds_read_b128 v[48:51], v236 offset:40960
    v_mfma_f32_16x16x32_bf16 v[168:171], v[72:75], v[136:139], v[168:171]
    ds_read_b128 v[52:55], v236 offset:41984
    v_mfma_f32_16x16x32_bf16 v[184:187], v[76:79], v[136:139], v[184:187]
    ds_read_b128 v[56:59], v236 offset:43008
    v_mfma_f32_16x16x32_bf16 v[200:203], v[80:83], v[136:139], v[200:203]
    ds_read_b128 v[60:63], v236 offset:44032
    v_mfma_f32_16x16x32_bf16 v[216:219], v[84:87], v[136:139], v[216:219]
    ds_read_b128 v[64:67], v236 offset:45056
    s_waitcnt vmcnt(15)
    v_mfma_f32_16x16x32_bf16 v[156:159], v[68:71], v[140:143], v[156:159]
    buffer_load_dwordx4 v[136:139], v233, s[68:71], s23 offen sc1
    v_mfma_f32_16x16x32_bf16 v[172:175], v[72:75], v[140:143], v[172:175]
    v_mfma_f32_16x16x32_bf16 v[188:191], v[76:79], v[140:143], v[188:191]
    v_mfma_f32_16x16x32_bf16 v[204:207], v[80:83], v[140:143], v[204:207]
    v_mfma_f32_16x16x32_bf16 v[220:223], v[84:87], v[140:143], v[220:223]
    s_waitcnt vmcnt(15)
    v_mfma_f32_16x16x32_bf16 v[160:163], v[68:71], v[144:147], v[160:163]
    buffer_load_dwordx4 v[140:143], v234, s[68:71], s23 offen sc1
    v_mfma_f32_16x16x32_bf16 v[176:179], v[72:75], v[144:147], v[176:179]
    v_mfma_f32_16x16x32_bf16 v[192:195], v[76:79], v[144:147], v[192:195]
    v_mfma_f32_16x16x32_bf16 v[208:211], v[80:83], v[144:147], v[208:211]
    v_mfma_f32_16x16x32_bf16 v[224:227], v[84:87], v[144:147], v[224:227]
    s_waitcnt vmcnt(15)
    v_mfma_f32_16x16x32_bf16 v[164:167], v[68:71], v[148:151], v[164:167]
    buffer_load_dwordx4 v[144:147], v235, s[68:71], s23 offen sc1
    v_mfma_f32_16x16x32_bf16 v[180:183], v[72:75], v[148:151], v[180:183]
    v_mfma_f32_16x16x32_bf16 v[196:199], v[76:79], v[148:151], v[196:199]
    v_mfma_f32_16x16x32_bf16 v[212:215], v[80:83], v[148:151], v[212:215]
    v_mfma_f32_16x16x32_bf16 v[228:231], v[84:87], v[148:151], v[228:231]
    s_waitcnt vmcnt(15) lgkmcnt(10)
    v_mfma_f32_16x16x32_bf16 v[152:155], v[8:11], v[244:247], v[152:155]
    buffer_load_dwordx4 v[148:151], v233, s[68:71], s56 offen sc1
    ds_read_b128 v[68:71], v236 offset:46080
    v_mfma_f32_16x16x32_bf16 v[168:171], v[12:15], v[244:247], v[168:171]
    ds_read_b128 v[72:75], v236 offset:47104
    v_mfma_f32_16x16x32_bf16 v[184:187], v[16:19], v[244:247], v[184:187]
    ds_read_b128 v[76:79], v236 offset:48128
    v_mfma_f32_16x16x32_bf16 v[200:203], v[20:23], v[244:247], v[200:203]
    ds_read_b128 v[80:83], v236 offset:49152
    v_mfma_f32_16x16x32_bf16 v[216:219], v[24:27], v[244:247], v[216:219]
    ds_read_b128 v[84:87], v236 offset:50176
    s_waitcnt vmcnt(15)
    v_mfma_f32_16x16x32_bf16 v[156:159], v[8:11], v[88:91], v[156:159]
    buffer_load_dwordx4 v[244:247], v233, s[68:71], s24 offen sc1
    v_mfma_f32_16x16x32_bf16 v[172:175], v[12:15], v[88:91], v[172:175]
    v_mfma_f32_16x16x32_bf16 v[188:191], v[16:19], v[88:91], v[188:191]
    v_mfma_f32_16x16x32_bf16 v[204:207], v[20:23], v[88:91], v[204:207]
    v_mfma_f32_16x16x32_bf16 v[220:223], v[24:27], v[88:91], v[220:223]
    s_waitcnt vmcnt(15)
    v_mfma_f32_16x16x32_bf16 v[160:163], v[8:11], v[92:95], v[160:163]
    buffer_load_dwordx4 v[88:91], v233, s[68:71], s57 offen sc1
    v_mfma_f32_16x16x32_bf16 v[176:179], v[12:15], v[92:95], v[176:179]
    v_mfma_f32_16x16x32_bf16 v[192:195], v[16:19], v[92:95], v[192:195]
    v_mfma_f32_16x16x32_bf16 v[208:211], v[20:23], v[92:95], v[208:211]
    v_mfma_f32_16x16x32_bf16 v[224:227], v[24:27], v[92:95], v[224:227]
    s_waitcnt vmcnt(15)
    v_mfma_f32_16x16x32_bf16 v[164:167], v[8:11], v[96:99], v[164:167]
    buffer_load_dwordx4 v[92:95], v233, s[68:71], s25 offen sc1
    v_mfma_f32_16x16x32_bf16 v[180:183], v[12:15], v[96:99], v[180:183]
    v_mfma_f32_16x16x32_bf16 v[196:199], v[16:19], v[96:99], v[196:199]
    v_mfma_f32_16x16x32_bf16 v[212:215], v[20:23], v[96:99], v[212:215]
    v_mfma_f32_16x16x32_bf16 v[228:231], v[24:27], v[96:99], v[228:231]
    s_waitcnt vmcnt(15) lgkmcnt(10)
    v_mfma_f32_16x16x32_bf16 v[152:155], v[28:31], v[100:103], v[152:155]
    buffer_load_dwordx4 v[96:99], v234, s[68:71], s56 offen sc1
    ds_read_b128 v[8:11], v1 offset:0
    v_mfma_f32_16x16x32_bf16 v[168:171], v[32:35], v[100:103], v[168:171]
    ds_read_b128 v[12:15], v1 offset:1024
    v_mfma_f32_16x16x32_bf16 v[184:187], v[36:39], v[100:103], v[184:187]
    ds_read_b128 v[16:19], v1 offset:2048
    v_mfma_f32_16x16x32_bf16 v[200:203], v[40:43], v[100:103], v[200:203]
    ds_read_b128 v[20:23], v1 offset:3072
    v_mfma_f32_16x16x32_bf16 v[216:219], v[44:47], v[100:103], v[216:219]
    ds_read_b128 v[24:27], v1 offset:4096
    s_waitcnt vmcnt(15)
    v_mfma_f32_16x16x32_bf16 v[156:159], v[28:31], v[104:107], v[156:159]
    buffer_load_dwordx4 v[100:103], v234, s[68:71], s24 offen sc1
    v_mfma_f32_16x16x32_bf16 v[172:175], v[32:35], v[104:107], v[172:175]
    v_mfma_f32_16x16x32_bf16 v[188:191], v[36:39], v[104:107], v[188:191]
    v_mfma_f32_16x16x32_bf16 v[204:207], v[40:43], v[104:107], v[204:207]
    v_mfma_f32_16x16x32_bf16 v[220:223], v[44:47], v[104:107], v[220:223]
    s_waitcnt vmcnt(15)
    v_mfma_f32_16x16x32_bf16 v[160:163], v[28:31], v[108:111], v[160:163]
    buffer_load_dwordx4 v[104:107], v234, s[68:71], s57 offen sc1
    v_mfma_f32_16x16x32_bf16 v[176:179], v[32:35], v[108:111], v[176:179]
    v_mfma_f32_16x16x32_bf16 v[192:195], v[36:39], v[108:111], v[192:195]
    v_mfma_f32_16x16x32_bf16 v[208:211], v[40:43], v[108:111], v[208:211]
    v_mfma_f32_16x16x32_bf16 v[224:227], v[44:47], v[108:111], v[224:227]
    s_waitcnt vmcnt(15)
    v_mfma_f32_16x16x32_bf16 v[164:167], v[28:31], v[112:115], v[164:167]
    buffer_load_dwordx4 v[108:111], v234, s[68:71], s25 offen sc1
    v_mfma_f32_16x16x32_bf16 v[180:183], v[32:35], v[112:115], v[180:183]
    v_mfma_f32_16x16x32_bf16 v[196:199], v[36:39], v[112:115], v[196:199]
    v_mfma_f32_16x16x32_bf16 v[212:215], v[40:43], v[112:115], v[212:215]
    v_mfma_f32_16x16x32_bf16 v[228:231], v[44:47], v[112:115], v[228:231]
    s_waitcnt vmcnt(15) lgkmcnt(10)
    v_mfma_f32_16x16x32_bf16 v[152:155], v[48:51], v[116:119], v[152:155]
    buffer_load_dwordx4 v[112:115], v235, s[68:71], s56 offen sc1
    ds_read_b128 v[28:31], v1 offset:5120
    v_mfma_f32_16x16x32_bf16 v[168:171], v[52:55], v[116:119], v[168:171]
    ds_read_b128 v[32:35], v1 offset:6144
    v_mfma_f32_16x16x32_bf16 v[184:187], v[56:59], v[116:119], v[184:187]
    ds_read_b128 v[36:39], v1 offset:7168
    v_mfma_f32_16x16x32_bf16 v[200:203], v[60:63], v[116:119], v[200:203]
    ds_read_b128 v[40:43], v1 offset:8192
    v_mfma_f32_16x16x32_bf16 v[216:219], v[64:67], v[116:119], v[216:219]
    ds_read_b128 v[44:47], v1 offset:9216
    s_waitcnt vmcnt(15)
    v_mfma_f32_16x16x32_bf16 v[156:159], v[48:51], v[120:123], v[156:159]
    buffer_load_dwordx4 v[116:119], v235, s[68:71], s24 offen sc1
    v_mfma_f32_16x16x32_bf16 v[172:175], v[52:55], v[120:123], v[172:175]
    v_mfma_f32_16x16x32_bf16 v[188:191], v[56:59], v[120:123], v[188:191]
    v_mfma_f32_16x16x32_bf16 v[204:207], v[60:63], v[120:123], v[204:207]
    v_mfma_f32_16x16x32_bf16 v[220:223], v[64:67], v[120:123], v[220:223]
    s_waitcnt vmcnt(15)
    v_mfma_f32_16x16x32_bf16 v[160:163], v[48:51], v[124:127], v[160:163]
    buffer_load_dwordx4 v[120:123], v235, s[68:71], s57 offen sc1
    v_mfma_f32_16x16x32_bf16 v[176:179], v[52:55], v[124:127], v[176:179]
    v_mfma_f32_16x16x32_bf16 v[192:195], v[56:59], v[124:127], v[192:195]
    v_mfma_f32_16x16x32_bf16 v[208:211], v[60:63], v[124:127], v[208:211]
    v_mfma_f32_16x16x32_bf16 v[224:227], v[64:67], v[124:127], v[224:227]
    s_waitcnt vmcnt(15)
    v_mfma_f32_16x16x32_bf16 v[164:167], v[48:51], v[128:131], v[164:167]
    buffer_load_dwordx4 v[124:127], v235, s[68:71], s25 offen sc1
    v_mfma_f32_16x16x32_bf16 v[180:183], v[52:55], v[128:131], v[180:183]
    v_mfma_f32_16x16x32_bf16 v[196:199], v[56:59], v[128:131], v[196:199]
    v_mfma_f32_16x16x32_bf16 v[212:215], v[60:63], v[128:131], v[212:215]
    v_mfma_f32_16x16x32_bf16 v[228:231], v[64:67], v[128:131], v[228:231]
    s_waitcnt vmcnt(15) lgkmcnt(10)
    v_mfma_f32_16x16x32_bf16 v[152:155], v[68:71], v[132:135], v[152:155]
    buffer_load_dwordx4 v[128:131], v232, s[68:71], s56 offen sc1
    ds_read_b128 v[48:51], v1 offset:40960
    v_mfma_f32_16x16x32_bf16 v[168:171], v[72:75], v[132:135], v[168:171]
    ds_read_b128 v[52:55], v1 offset:41984
    v_mfma_f32_16x16x32_bf16 v[184:187], v[76:79], v[132:135], v[184:187]
    ds_read_b128 v[56:59], v1 offset:43008
    v_mfma_f32_16x16x32_bf16 v[200:203], v[80:83], v[132:135], v[200:203]
    ds_read_b128 v[60:63], v1 offset:44032
    v_mfma_f32_16x16x32_bf16 v[216:219], v[84:87], v[132:135], v[216:219]
    ds_read_b128 v[64:67], v1 offset:45056
    s_waitcnt vmcnt(15)
    v_mfma_f32_16x16x32_bf16 v[156:159], v[68:71], v[136:139], v[156:159]
    buffer_load_dwordx4 v[132:135], v232, s[68:71], s24 offen sc1
    v_mfma_f32_16x16x32_bf16 v[172:175], v[72:75], v[136:139], v[172:175]
    v_mfma_f32_16x16x32_bf16 v[188:191], v[76:79], v[136:139], v[188:191]
    v_mfma_f32_16x16x32_bf16 v[204:207], v[80:83], v[136:139], v[204:207]
    v_mfma_f32_16x16x32_bf16 v[220:223], v[84:87], v[136:139], v[220:223]
    s_waitcnt vmcnt(15)
    v_mfma_f32_16x16x32_bf16 v[160:163], v[68:71], v[140:143], v[160:163]
    buffer_load_dwordx4 v[136:139], v232, s[68:71], s57 offen sc1
    v_mfma_f32_16x16x32_bf16 v[176:179], v[72:75], v[140:143], v[176:179]
    v_mfma_f32_16x16x32_bf16 v[192:195], v[76:79], v[140:143], v[192:195]
    v_mfma_f32_16x16x32_bf16 v[208:211], v[80:83], v[140:143], v[208:211]
    v_mfma_f32_16x16x32_bf16 v[224:227], v[84:87], v[140:143], v[224:227]
    s_waitcnt vmcnt(15)
    v_mfma_f32_16x16x32_bf16 v[164:167], v[68:71], v[144:147], v[164:167]
    buffer_load_dwordx4 v[140:143], v232, s[68:71], s25 offen sc1
    v_mfma_f32_16x16x32_bf16 v[180:183], v[72:75], v[144:147], v[180:183]
    v_mfma_f32_16x16x32_bf16 v[196:199], v[76:79], v[144:147], v[196:199]
    v_mfma_f32_16x16x32_bf16 v[212:215], v[80:83], v[144:147], v[212:215]
    v_mfma_f32_16x16x32_bf16 v[228:231], v[84:87], v[144:147], v[228:231]
    s_waitcnt vmcnt(15) lgkmcnt(10)
    v_mfma_f32_16x16x32_bf16 v[156:159], v[8:11], v[148:151], v[156:159]
    ds_read_b128 v[68:71], v1 offset:46080
    v_mfma_f32_16x16x32_bf16 v[172:175], v[12:15], v[148:151], v[172:175]
    ds_read_b128 v[72:75], v1 offset:47104
    v_mfma_f32_16x16x32_bf16 v[188:191], v[16:19], v[148:151], v[188:191]
    ds_read_b128 v[76:79], v1 offset:48128
    v_mfma_f32_16x16x32_bf16 v[204:207], v[20:23], v[148:151], v[204:207]
    ds_read_b128 v[80:83], v1 offset:49152
    v_mfma_f32_16x16x32_bf16 v[220:223], v[24:27], v[148:151], v[220:223]
    ds_read_b128 v[84:87], v1 offset:50176
    s_waitcnt vmcnt(14) lgkmcnt(10)
    v_mfma_f32_16x16x32_bf16 v[156:159], v[28:31], v[244:247], v[156:159]
    v_mfma_f32_16x16x32_bf16 v[172:175], v[32:35], v[244:247], v[172:175]
    v_mfma_f32_16x16x32_bf16 v[188:191], v[36:39], v[244:247], v[188:191]
    v_mfma_f32_16x16x32_bf16 v[204:207], v[40:43], v[244:247], v[204:207]
    v_mfma_f32_16x16x32_bf16 v[220:223], v[44:47], v[244:247], v[220:223]
    s_waitcnt vmcnt(13) lgkmcnt(5)
    v_mfma_f32_16x16x32_bf16 v[156:159], v[48:51], v[88:91], v[156:159]
    v_mfma_f32_16x16x32_bf16 v[172:175], v[52:55], v[88:91], v[172:175]
    v_mfma_f32_16x16x32_bf16 v[188:191], v[56:59], v[88:91], v[188:191]
    v_mfma_f32_16x16x32_bf16 v[204:207], v[60:63], v[88:91], v[204:207]
    v_mfma_f32_16x16x32_bf16 v[220:223], v[64:67], v[88:91], v[220:223]
    s_waitcnt vmcnt(12) lgkmcnt(0)
    v_mfma_f32_16x16x32_bf16 v[156:159], v[68:71], v[92:95], v[156:159]
    v_mfma_f32_16x16x32_bf16 v[172:175], v[72:75], v[92:95], v[172:175]
    v_mfma_f32_16x16x32_bf16 v[188:191], v[76:79], v[92:95], v[188:191]
    v_mfma_f32_16x16x32_bf16 v[204:207], v[80:83], v[92:95], v[204:207]
    v_mfma_f32_16x16x32_bf16 v[220:223], v[84:87], v[92:95], v[220:223]
    s_waitcnt vmcnt(11)
    v_mfma_f32_16x16x32_bf16 v[160:163], v[8:11], v[96:99], v[160:163]
    v_mfma_f32_16x16x32_bf16 v[176:179], v[12:15], v[96:99], v[176:179]
    v_mfma_f32_16x16x32_bf16 v[192:195], v[16:19], v[96:99], v[192:195]
    v_mfma_f32_16x16x32_bf16 v[208:211], v[20:23], v[96:99], v[208:211]
    v_mfma_f32_16x16x32_bf16 v[224:227], v[24:27], v[96:99], v[224:227]
    s_waitcnt vmcnt(10)
    v_mfma_f32_16x16x32_bf16 v[160:163], v[28:31], v[100:103], v[160:163]
    ds_write_b128 v1, v[156:159] offset:0
    v_mfma_f32_16x16x32_bf16 v[176:179], v[32:35], v[100:103], v[176:179]
    ds_write_b128 v1, v[172:175] offset:1024
    v_mfma_f32_16x16x32_bf16 v[192:195], v[36:39], v[100:103], v[192:195]
    ds_write_b128 v1, v[188:191] offset:2048
    v_mfma_f32_16x16x32_bf16 v[208:211], v[40:43], v[100:103], v[208:211]
    ds_write_b128 v1, v[204:207] offset:3072
    v_mfma_f32_16x16x32_bf16 v[224:227], v[44:47], v[100:103], v[224:227]
    ds_write_b128 v1, v[220:223] offset:4096
    s_waitcnt vmcnt(9)
    v_mfma_f32_16x16x32_bf16 v[160:163], v[48:51], v[104:107], v[160:163]
    v_mfma_f32_16x16x32_bf16 v[176:179], v[52:55], v[104:107], v[176:179]
    v_mfma_f32_16x16x32_bf16 v[192:195], v[56:59], v[104:107], v[192:195]
    v_mfma_f32_16x16x32_bf16 v[208:211], v[60:63], v[104:107], v[208:211]
    v_mfma_f32_16x16x32_bf16 v[224:227], v[64:67], v[104:107], v[224:227]
    s_waitcnt vmcnt(8)
    v_mfma_f32_16x16x32_bf16 v[160:163], v[68:71], v[108:111], v[160:163]
    v_mfma_f32_16x16x32_bf16 v[176:179], v[72:75], v[108:111], v[176:179]
    v_mfma_f32_16x16x32_bf16 v[192:195], v[76:79], v[108:111], v[192:195]
    v_mfma_f32_16x16x32_bf16 v[208:211], v[80:83], v[108:111], v[208:211]
    v_mfma_f32_16x16x32_bf16 v[224:227], v[84:87], v[108:111], v[224:227]
    s_waitcnt vmcnt(7)
    v_mfma_f32_16x16x32_bf16 v[164:167], v[8:11], v[112:115], v[164:167]
    v_mfma_f32_16x16x32_bf16 v[180:183], v[12:15], v[112:115], v[180:183]
    v_mfma_f32_16x16x32_bf16 v[196:199], v[16:19], v[112:115], v[196:199]
    v_mfma_f32_16x16x32_bf16 v[212:215], v[20:23], v[112:115], v[212:215]
    v_mfma_f32_16x16x32_bf16 v[228:231], v[24:27], v[112:115], v[228:231]
    s_waitcnt vmcnt(6)
    v_mfma_f32_16x16x32_bf16 v[164:167], v[28:31], v[116:119], v[164:167]
    ds_write_b128 v1, v[160:163] offset:40960
    v_mfma_f32_16x16x32_bf16 v[180:183], v[32:35], v[116:119], v[180:183]
    ds_write_b128 v1, v[176:179] offset:41984
    v_mfma_f32_16x16x32_bf16 v[196:199], v[36:39], v[116:119], v[196:199]
    ds_write_b128 v1, v[192:195] offset:43008
    v_mfma_f32_16x16x32_bf16 v[212:215], v[40:43], v[116:119], v[212:215]
    ds_write_b128 v1, v[208:211] offset:44032
    v_mfma_f32_16x16x32_bf16 v[228:231], v[44:47], v[116:119], v[228:231]
    ds_write_b128 v1, v[224:227] offset:45056
    s_waitcnt vmcnt(5)
    v_mfma_f32_16x16x32_bf16 v[164:167], v[48:51], v[120:123], v[164:167]
    v_mfma_f32_16x16x32_bf16 v[180:183], v[52:55], v[120:123], v[180:183]
    v_mfma_f32_16x16x32_bf16 v[196:199], v[56:59], v[120:123], v[196:199]
    v_mfma_f32_16x16x32_bf16 v[212:215], v[60:63], v[120:123], v[212:215]
    v_mfma_f32_16x16x32_bf16 v[228:231], v[64:67], v[120:123], v[228:231]
    s_waitcnt vmcnt(4)
    v_mfma_f32_16x16x32_bf16 v[164:167], v[68:71], v[124:127], v[164:167]
    v_mfma_f32_16x16x32_bf16 v[180:183], v[72:75], v[124:127], v[180:183]
    v_mfma_f32_16x16x32_bf16 v[196:199], v[76:79], v[124:127], v[196:199]
    v_mfma_f32_16x16x32_bf16 v[212:215], v[80:83], v[124:127], v[212:215]
    v_mfma_f32_16x16x32_bf16 v[228:231], v[84:87], v[124:127], v[228:231]
    s_sub_u32 s43, s19, 1
    s_and_b32 s43, s43, 3
    s_mul_i32 s43, s43, 10240
    s_add_u32 s43, s43, 0
    v_add_u32 v233, s43, v3
    s_sub_u32 s43, s19, 2
    s_and_b32 s43, s43, 3
    s_mul_i32 s43, s43, 10240
    s_add_u32 s43, s43, 40960
    v_add_u32 v234, s43, v3
    s_sub_u32 s43, s19, 3
    s_and_b32 s43, s43, 3
    s_mul_i32 s43, s43, 10240
    s_add_u32 s43, s43, 81920
    v_add_u32 v235, s43, v3
    s_waitcnt vmcnt(3)
    v_mfma_f32_16x16x32_bf16 v[152:155], v[8:11], v[128:131], v[152:155]
    v_mfma_f32_16x16x32_bf16 v[168:171], v[12:15], v[128:131], v[168:171]
    v_mfma_f32_16x16x32_bf16 v[184:187], v[16:19], v[128:131], v[184:187]
    v_mfma_f32_16x16x32_bf16 v[200:203], v[20:23], v[128:131], v[200:203]
    v_mfma_f32_16x16x32_bf16 v[216:219], v[24:27], v[128:131], v[216:219]
    s_waitcnt vmcnt(2)
    v_mfma_f32_16x16x32_bf16 v[152:155], v[28:31], v[132:135], v[152:155]
    ds_write_b128 v236, v[164:167] offset:0
    v_mfma_f32_16x16x32_bf16 v[168:171], v[32:35], v[132:135], v[168:171]
    ds_write_b128 v236, v[180:183] offset:1024
    v_mfma_f32_16x16x32_bf16 v[184:187], v[36:39], v[132:135], v[184:187]
    ds_write_b128 v236, v[196:199] offset:2048
    v_mfma_f32_16x16x32_bf16 v[200:203], v[40:43], v[132:135], v[200:203]
    ds_write_b128 v236, v[212:215] offset:3072
    v_mfma_f32_16x16x32_bf16 v[216:219], v[44:47], v[132:135], v[216:219]
    ds_write_b128 v236, v[228:231] offset:4096
    s_waitcnt lgkmcnt(0)
    s_barrier
    s_waitcnt vmcnt(1)
    v_mfma_f32_16x16x32_bf16 v[152:155], v[48:51], v[136:139], v[152:155]
    ds_read_b128 v[156:159], v233 offset:0
    ds_read_b128 v[160:163], v234 offset:0
    v_mfma_f32_16x16x32_bf16 v[168:171], v[52:55], v[136:139], v[168:171]
    ds_read_b128 v[164:167], v235 offset:0
    ds_read_b128 v[172:175], v233 offset:1024
    v_mfma_f32_16x16x32_bf16 v[184:187], v[56:59], v[136:139], v[184:187]
    ds_read_b128 v[176:179], v234 offset:1024
    ds_read_b128 v[180:183], v235 offset:1024
    v_mfma_f32_16x16x32_bf16 v[200:203], v[60:63], v[136:139], v[200:203]
    ds_read_b128 v[188:191], v233 offset:2048
    ds_read_b128 v[192:195], v234 offset:2048
    v_mfma_f32_16x16x32_bf16 v[216:219], v[64:67], v[136:139], v[216:219]
    ds_read_b128 v[196:199], v235 offset:2048
    ds_read_b128 v[204:207], v233 offset:3072
    s_waitcnt vmcnt(0)
    v_mfma_f32_16x16x32_bf16 v[152:155], v[68:71], v[140:143], v[152:155]
    ds_read_b128 v[208:211], v234 offset:3072
    ds_read_b128 v[212:215], v235 offset:3072
    v_mfma_f32_16x16x32_bf16 v[168:171], v[72:75], v[140:143], v[168:171]
    ds_read_b128 v[220:223], v233 offset:4096
    ds_read_b128 v[224:227], v234 offset:4096
    v_mfma_f32_16x16x32_bf16 v[184:187], v[76:79], v[140:143], v[184:187]
    ds_read_b128 v[228:231], v235 offset:4096
    v_mfma_f32_16x16x32_bf16 v[200:203], v[80:83], v[140:143], v[200:203]
    v_mfma_f32_16x16x32_bf16 v[216:219], v[84:87], v[140:143], v[216:219]
    v_and_b32 v7, 15, v2
    v_mul_u32_u24 v7, 1280, v7
    v_lshrrev_b32 v6, 4, v2
    v_lshl_add_u32 v5, v6, 3, v7
    v_and_b32 v4, 1, v6
    v_lshl_add_u32 v7, v4, 5, v7
    v_lshrrev_b32 v6, 1, v6
    v_lshl_add_u32 v7, v6, 4, v7
    s_lshl_b32 s36, s50, 6
    s_lshl_b32 s37, s19, 4
    s_add_u32 s36, s36, s37
    s_mul_i32 s36, s36, 1280
    s_mul_i32 s37, s51, 160
    s_add_u32 s36, s36, s37
    s_waitcnt lgkmcnt(12)
    v_add_f32 v156, v156, v160
    v_add_f32 v157, v157, v161
    v_add_f32 v158, v158, v162
    v_add_f32 v159, v159, v163
    v_add_f32 v152, v152, v164
    v_add_f32 v153, v153, v165
    v_add_f32 v154, v154, v166
    v_add_f32 v155, v155, v167
    v_add_f32 v152, v152, v156
    v_add_f32 v153, v153, v157
    v_add_f32 v154, v154, v158
    v_add_f32 v155, v155, v159
    v_cvt_pk_bf16_f32 v8, v152, v153
    v_cvt_pk_bf16_f32 v9, v154, v155
    s_waitcnt lgkmcnt(9)
    v_add_f32 v172, v172, v176
    v_add_f32 v173, v173, v177
    v_add_f32 v174, v174, v178
    v_add_f32 v175, v175, v179
    v_add_f32 v168, v168, v180
    v_add_f32 v169, v169, v181
    v_add_f32 v170, v170, v182
    v_add_f32 v171, v171, v183
    v_add_f32 v168, v168, v172
    v_add_f32 v169, v169, v173
    v_add_f32 v170, v170, v174
    v_add_f32 v171, v171, v175
    v_cvt_pk_bf16_f32 v10, v168, v169
    v_cvt_pk_bf16_f32 v11, v170, v171
    s_nop 1
    v_permlane16_swap_b32 v8, v10
    v_permlane16_swap_b32 v9, v11
    buffer_store_dwordx4 v[8:11], v7, s[72:75], s36 offen offset:0
    s_waitcnt lgkmcnt(6)
    v_add_f32 v188, v188, v192
    v_add_f32 v189, v189, v193
    v_add_f32 v190, v190, v194
    v_add_f32 v191, v191, v195
    v_add_f32 v184, v184, v196
    v_add_f32 v185, v185, v197
    v_add_f32 v186, v186, v198
    v_add_f32 v187, v187, v199
    v_add_f32 v184, v184, v188
    v_add_f32 v185, v185, v189
    v_add_f32 v186, v186, v190
    v_add_f32 v187, v187, v191
    v_cvt_pk_bf16_f32 v12, v184, v185
    v_cvt_pk_bf16_f32 v13, v186, v187
    s_waitcnt lgkmcnt(3)
    v_add_f32 v204, v204, v208
    v_add_f32 v205, v205, v209
    v_add_f32 v206, v206, v210
    v_add_f32 v207, v207, v211
    v_add_f32 v200, v200, v212
    v_add_f32 v201, v201, v213
    v_add_f32 v202, v202, v214
    v_add_f32 v203, v203, v215
    v_add_f32 v200, v200, v204
    v_add_f32 v201, v201, v205
    v_add_f32 v202, v202, v206
    v_add_f32 v203, v203, v207
    v_cvt_pk_bf16_f32 v14, v200, v201
    v_cvt_pk_bf16_f32 v15, v202, v203
    s_nop 1
    v_permlane16_swap_b32 v12, v14
    v_permlane16_swap_b32 v13, v15
    buffer_store_dwordx4 v[12:15], v7, s[72:75], s36 offen offset:64
    s_waitcnt lgkmcnt(0)
    v_add_f32 v220, v220, v224
    v_add_f32 v221, v221, v225
    v_add_f32 v222, v222, v226
    v_add_f32 v223, v223, v227
    v_add_f32 v216, v216, v228
    v_add_f32 v217, v217, v229
    v_add_f32 v218, v218, v230
    v_add_f32 v219, v219, v231
    v_add_f32 v216, v216, v220
    v_add_f32 v217, v217, v221
    v_add_f32 v218, v218, v222
    v_add_f32 v219, v219, v223
    v_cvt_pk_bf16_f32 v16, v216, v217
    v_cvt_pk_bf16_f32 v17, v218, v219
    buffer_store_dwordx2 v[16:17], v5, s[72:75], s36 offen offset:128
    s_endpgm
L_comp_standa:
    s_setprio 1
    s_lshl_b32 s34, s16, 4
    s_add_u32 s34, s34, s17
    s_min_u32 s35, s34, 239
    s_mul_i32 s52, s35, 2731
    s_lshr_b32 s52, s52, 16
    s_mul_i32 s53, s52, 24
    s_sub_u32 s53, s35, s53
    v_lshrrev_b32 v3, 3, v2
    v_and_b32 v4, 7, v2
    v_mul_u32_u24 v3, 1280, v3
    v_lshl_add_u32 v3, v4, 4, v3
    s_lshl_b32 s37, s53, 3
    s_add_u32 s37, s37, s19
    s_mul_i32 s37, s37, 10240
    s_lshl_b32 s38, s52, 7
    s_add_u32 s37, s37, s38
    s_add_u32 s38, s37, 40960
    s_lshl_b32 s39, s19, 10
    s_add_u32 m0, s39, 122880
    v_mov_b32 v10, 0
    s_waitcnt lgkmcnt(0)
    s_mov_b32 s20, s10
    s_and_b32 s21, s11, 0xffff
    s_mov_b32 s22, 1966080
    s_mov_b32 s23, 0x20000
    s_cmp_ge_u32 s34, 240
    s_cselect_b32 s22, 0, s22
    buffer_load_dwordx4 v3, s[20:23], s37 offen lds
    s_add_u32 m0, s39, 126976
    s_add_u32 s24, s46, 8388608
    s_addc_u32 s25, s47, 0
    s_and_b32 s25, s25, 0xffff
    s_mov_b32 s26, 1966080
    s_mov_b32 s27, 0x20000
    s_cmp_ge_u32 s34, 240
    s_cselect_b32 s26, 0, s26
    buffer_load_dwordx4 v3, s[20:23], s38 offen lds
    s_cmp_lg_u32 s19, 3
    s_cbranch_scc1 L_nocpf_standa
    s_cmp_lg_u32 s34, 255
    s_cbranch_scc1 L_nocpf_standa
    s_memrealtime s[36:37]
    s_waitcnt lgkmcnt(0)
    s_or_b32 s37, s37, 0x80000000
    v_mov_b32 v12, s36
    v_mov_b32 v13, s37
    s_mov_b64 exec, 1
    global_store_dwordx2 v10, v[12:13], s[14:15] sc1
    s_mov_b64 exec, -1
L_nocpf_standa:
    s_lshr_b32 s32, s19, 1
    s_and_b32 s33, s19, 1
    s_lshl_b32 s35, s52, 2
    s_add_u32 s35, s35, s19
    s_mul_i32 s54, s35, 13108
    s_lshr_b32 s54, s54, 16
    s_mul_i32 s36, s54, 5
    s_sub_u32 s36, s35, s36
    s_mul_i32 s54, s54, 24
    s_add_u32 s54, s54, s53
    s_mul_i32 s54, s54, 10
    s_add_u32 s54, s54, s36
    s_lshl_b32 s54, s54, 10
    s_add_u32 s55, s54, 5120
    s_mul_i32 s35, s53, 43
    s_lshr_b32 s35, s35, 8
    s_mul_i32 s36, s35, 6
    s_sub_u32 s36, s53, s36
    s_lshl_b32 s37, s52, 2
    s_add_u32 s35, s35, s37
    s_lshl_b32 s35, s35, 7
    s_lshl_b32 s36, s36, 3
    s_add_u32 s35, s35, s36
    s_add_u32 s35, s35, 12648448
    s_cmp_ge_u32 s34, 240
    s_cselect_b32 s35, 12656640, s35
    s_add_u32 s58, s46, s35
    s_addc_u32 s59, s47, 0
    v_and_b32 v5, 15, v2
    v_lshrrev_b32 v6, 4, v2
    v_lshlrev_b32 v14, 10, v6
    v_bfe_u32 v7, v2, 2, 2
    v_lshl_add_u32 v14, v7, 7, v14
    v_and_b32 v8, 3, v2
    v_lshl_add_u32 v14, v8, 3, v14
    s_lshl_b32 s35, s19, 5
    s_add_u32 s35, s35, 122880
    v_add_u32 v14, s35, v14
    v_lshlrev_b32 v15, 4, v2
    v_lshrrev_b32 v9, 1, v5
    v_xor_b32 v9, v9, v6
    s_lshl_b32 s35, s32, 13
    v_lshlrev_b32 v3, 7, v5
    v_add_u32 v3, s35, v3
    v_lshl_add_u32 v16, v9, 4, v3
    v_xor_b32 v17, 64, v16
    v_lshl_add_u32 v9, v6, 3, v7
    v_mul_u32_u24 v9, 192, v9
    v_lshl_add_u32 v9, v8, 3, v9
    v_add_u32 v9, 16384, v9
    v_and_b32 v4, 1, v6
    s_mul_i32 s35, s33, 3
    s_add_u32 s36, s35, 0
    v_xor_b32 v3, s36, v4
    v_lshl_add_u32 v18, v3, 5, v9
    s_add_u32 s36, s35, 1
    v_xor_b32 v3, s36, v4
    v_lshl_add_u32 v19, v3, 5, v9
    s_add_u32 s36, s35, 2
    v_xor_b32 v3, s36, v4
    v_lshl_add_u32 v20, v3, 5, v9
    v_lshlrev_b32 v8, 10, v4
    v_lshrrev_b32 v3, 1, v6
    v_lshl_add_u32 v8, v3, 8, v8
    v_lshl_add_u32 v8, v5, 4, v8
    s_mov_b32 s28, s46
    s_and_b32 s29, s47, 0xffff
    s_mov_b32 s30, 6291456
    s_mov_b32 s31, 0x20000
    s_lshl_b32 s36, s16, 1
    s_add_u32 s36, s36, s32
    s_mul_i32 s36, s36, 196608
    s_mul_i32 s37, s17, 6
    s_add_u32 s37, s37, s35
    s_add_u32 s38, s37, 0
    s_lshr_b32 s39, s38, 1
    s_lshl_b32 s39, s39, 12
    s_and_b32 s38, s38, 1
    s_lshl_b32 s38, s38, 9
    s_add_u32 s38, s38, s39
    s_add_u32 s64, s38, s36
    s_add_u32 s38, s37, 1
    s_lshr_b32 s39, s38, 1
    s_lshl_b32 s39, s39, 12
    s_and_b32 s38, s38, 1
    s_lshl_b32 s38, s38, 9
    s_add_u32 s38, s38, s39
    s_add_u32 s65, s38, s36
    s_add_u32 s38, s37, 2
    s_lshr_b32 s39, s38, 1
    s_lshl_b32 s39, s39, 12
    s_and_b32 s38, s38, 1
    s_lshl_b32 s38, s38, 9
    s_add_u32 s38, s38, s39
    s_add_u32 s66, s38, s36
    s_mov_b32 s44, 0xbfb8aa3b
    s_lshl_b32 s38, s34, 7
    s_lshl_b32 s39, s19, 3
    s_add_u32 s38, s38, s39
    s_add_u32 s38, s38, 12582912
    s_add_u32 s62, s46, s38
    s_addc_u32 s63, s47, 0
    v_mov_b32 v9, 131072
    v_mov_b32 v128, 0
    v_mov_b32 v129, 0
    v_mov_b32 v130, 0
    v_mov_b32 v131, 0
    v_mov_b32 v132, 0
    v_mov_b32 v133, 0
    v_mov_b32 v134, 0
    v_mov_b32 v135, 0
    v_mov_b32 v136, 0
    v_mov_b32 v137, 0
    v_mov_b32 v138, 0
    v_mov_b32 v139, 0
    v_mov_b32 v140, 0
    v_mov_b32 v141, 0
    v_mov_b32 v142, 0
    v_mov_b32 v143, 0
    v_mov_b32 v144, 0
    v_mov_b32 v145, 0
    v_mov_b32 v146, 0
    v_mov_b32 v147, 0
    v_mov_b32 v148, 0
    v_mov_b32 v149, 0
    v_mov_b32 v150, 0
    v_mov_b32 v151, 0
    v_mov_b32 v152, 0
    v_mov_b32 v153, 0
    v_mov_b32 v154, 0
    v_mov_b32 v155, 0
    v_mov_b32 v156, 0
    v_mov_b32 v157, 0
    v_mov_b32 v158, 0
    v_mov_b32 v159, 0
    v_mov_b32 v160, 0
    v_mov_b32 v161, 0
    v_mov_b32 v162, 0
    v_mov_b32 v163, 0
    v_mov_b32 v164, 0
    v_mov_b32 v165, 0
    v_mov_b32 v166, 0
    v_mov_b32 v167, 0
    v_mov_b32 v168, 0
    v_mov_b32 v169, 0
    v_mov_b32 v170, 0
    v_mov_b32 v171, 0
    v_mov_b32 v172, 0
    v_mov_b32 v173, 0
    v_mov_b32 v174, 0
    v_mov_b32 v175, 0
    v_mov_b32 v176, 0
    v_mov_b32 v177, 0
    v_mov_b32 v178, 0
    v_mov_b32 v179, 0
    v_mov_b32 v180, 0
    v_mov_b32 v181, 0
    v_mov_b32 v182, 0
    v_mov_b32 v183, 0
    v_mov_b32 v184, 0
    v_mov_b32 v185, 0
    v_mov_b32 v186, 0
    v_mov_b32 v187, 0
    v_mov_b32 v188, 0
    v_mov_b32 v189, 0
    v_mov_b32 v190, 0
    v_mov_b32 v191, 0
    v_mov_b32 v192, 0
    v_mov_b32 v193, 0
    v_mov_b32 v194, 0
    v_mov_b32 v195, 0
    v_mov_b32 v196, 0
    v_mov_b32 v197, 0
    v_mov_b32 v198, 0
    v_mov_b32 v199, 0
    v_mov_b32 v200, 0
    v_mov_b32 v201, 0
    v_mov_b32 v202, 0
    v_mov_b32 v203, 0
    v_mov_b32 v204, 0
    v_mov_b32 v205, 0
    v_mov_b32 v206, 0
    v_mov_b32 v207, 0
    v_mov_b32 v208, 0
    v_mov_b32 v209, 0
    v_mov_b32 v210, 0
    v_mov_b32 v211, 0
    v_mov_b32 v212, 0
    v_mov_b32 v213, 0
    v_mov_b32 v214, 0
    v_mov_b32 v215, 0
    v_mov_b32 v216, 0
    v_mov_b32 v217, 0
    v_mov_b32 v218, 0
    v_mov_b32 v219, 0
    v_mov_b32 v220, 0
    v_mov_b32 v221, 0
    v_mov_b32 v222, 0
    v_mov_b32 v223, 0
    s_mov_b32 s40, 0
    s_mov_b32 s41, 0
    s_mov_b32 s43, 4294885376
    s_barrier
    ds_read_b64_tr_b16 v[24:25], v18 offset:0
    ds_read_b64_tr_b16 v[26:27], v18 offset:768
    ds_read_b128 v[48:51], v16 offset:0
    ds_read_b128 v[52:55], v16 offset:2048
    ds_read_b128 v[56:59], v16 offset:4096
    ds_read_b128 v[60:63], v16 offset:6144
    ds_read_b64_tr_b16 v[28:29], v18 offset:12288
    ds_read_b64_tr_b16 v[30:31], v18 offset:13056
    ds_read_b64_tr_b16 v[32:33], v19 offset:0
    ds_read_b64_tr_b16 v[34:35], v19 offset:768
    ds_read_b64_tr_b16 v[36:37], v19 offset:12288
    ds_read_b64_tr_b16 v[38:39], v19 offset:13056
    ds_read_b64_tr_b16 v[40:41], v20 offset:0
    ds_read_b64_tr_b16 v[42:43], v20 offset:768
    ds_read_b64_tr_b16 v[44:45], v20 offset:12288
    ds_read_b64_tr_b16 v[46:47], v20 offset:13056
L_cl_standa:
    s_waitcnt lgkmcnt(0)
    v_mfma_f32_16x16x32_bf16 v[128:131], v[24:27], v[48:51], v[128:131]
    ds_read_b64_tr_b16 v[64:65], v18 offset:6144
    v_mfma_f32_16x16x32_bf16 v[136:139], v[24:27], v[52:55], v[136:139]
    ds_read_b64_tr_b16 v[66:67], v18 offset:6912
    v_mfma_f32_16x16x32_bf16 v[144:147], v[24:27], v[56:59], v[144:147]
    ds_read_b128 v[88:91], v17 offset:0
    v_mfma_f32_16x16x32_bf16 v[152:155], v[24:27], v[60:63], v[152:155]
    ds_read_b128 v[92:95], v17 offset:2048
    v_mfma_f32_16x16x32_bf16 v[132:135], v[28:31], v[48:51], v[132:135]
    ds_read_b128 v[96:99], v17 offset:4096
    v_mfma_f32_16x16x32_bf16 v[140:143], v[28:31], v[52:55], v[140:143]
    ds_read_b128 v[100:103], v17 offset:6144
    v_mfma_f32_16x16x32_bf16 v[148:151], v[28:31], v[56:59], v[148:151]
    ds_read_b64_tr_b16 v[68:69], v18 offset:18432
    v_mfma_f32_16x16x32_bf16 v[156:159], v[28:31], v[60:63], v[156:159]
    ds_read_b64_tr_b16 v[70:71], v18 offset:19200
    v_mfma_f32_16x16x32_bf16 v[160:163], v[32:35], v[48:51], v[160:163]
    ds_read_b64_tr_b16 v[72:73], v19 offset:6144
    v_mfma_f32_16x16x32_bf16 v[168:171], v[32:35], v[52:55], v[168:171]
    ds_read_b64_tr_b16 v[74:75], v19 offset:6912
    v_mfma_f32_16x16x32_bf16 v[176:179], v[32:35], v[56:59], v[176:179]
    ds_read_b64_tr_b16 v[76:77], v19 offset:18432
    v_mfma_f32_16x16x32_bf16 v[184:187], v[32:35], v[60:63], v[184:187]
    ds_read_b64_tr_b16 v[78:79], v19 offset:19200
    v_mfma_f32_16x16x32_bf16 v[164:167], v[36:39], v[48:51], v[164:167]
    ds_read_b64_tr_b16 v[80:81], v20 offset:6144
    v_mfma_f32_16x16x32_bf16 v[172:175], v[36:39], v[52:55], v[172:175]
    ds_read_b64_tr_b16 v[82:83], v20 offset:6912
    v_mfma_f32_16x16x32_bf16 v[180:183], v[36:39], v[56:59], v[180:183]
    ds_read_b64_tr_b16 v[84:85], v20 offset:18432
    v_mfma_f32_16x16x32_bf16 v[188:191], v[36:39], v[60:63], v[188:191]
    ds_read_b64_tr_b16 v[86:87], v20 offset:19200
    v_mfma_f32_16x16x32_bf16 v[192:195], v[40:43], v[48:51], v[192:195]
    s_add_u32 s40, s40, 1
    s_add_u32 s41, s41, 40960
    v_mfma_f32_16x16x32_bf16 v[200:203], v[40:43], v[52:55], v[200:203]
    s_cmp_eq_u32 s41, 122880
    s_cselect_b32 s41, 0, s41
    v_mfma_f32_16x16x32_bf16 v[208:211], v[40:43], v[56:59], v[208:211]
    s_cselect_b32 s42, s43, 40960
    v_add_u32 v16, s42, v16
    v_mfma_f32_16x16x32_bf16 v[216:219], v[40:43], v[60:63], v[216:219]
    v_add_u32 v17, s42, v17
    v_add_u32 v18, s42, v18
    v_mfma_f32_16x16x32_bf16 v[196:199], v[44:47], v[48:51], v[196:199]
    v_add_u32 v19, s42, v19
    v_add_u32 v20, s42, v20
    v_mfma_f32_16x16x32_bf16 v[204:207], v[44:47], v[52:55], v[204:207]
    s_bitcmp1_b32 0x216, s40
    v_mfma_f32_16x16x32_bf16 v[212:215], v[44:47], v[56:59], v[212:215]
    v_mfma_f32_16x16x32_bf16 v[220:223], v[44:47], v[60:63], v[220:223]
    s_cbranch_scc1 L_hook_standa
    s_waitcnt lgkmcnt(0)
    s_barrier
L_hookr_standa:
    v_mfma_f32_16x16x32_bf16 v[128:131], v[64:67], v[88:91], v[128:131]
    ds_read_b64_tr_b16 v[24:25], v18 offset:0
    v_mfma_f32_16x16x32_bf16 v[136:139], v[64:67], v[92:95], v[136:139]
    ds_read_b64_tr_b16 v[26:27], v18 offset:768
    v_mfma_f32_16x16x32_bf16 v[144:147], v[64:67], v[96:99], v[144:147]
    ds_read_b128 v[48:51], v16 offset:0
    v_mfma_f32_16x16x32_bf16 v[152:155], v[64:67], v[100:103], v[152:155]
    ds_read_b128 v[52:55], v16 offset:2048
    v_mfma_f32_16x16x32_bf16 v[132:135], v[68:71], v[88:91], v[132:135]
    ds_read_b128 v[56:59], v16 offset:4096
    v_mfma_f32_16x16x32_bf16 v[140:143], v[68:71], v[92:95], v[140:143]
    ds_read_b128 v[60:63], v16 offset:6144
    v_mfma_f32_16x16x32_bf16 v[148:151], v[68:71], v[96:99], v[148:151]
    ds_read_b64_tr_b16 v[28:29], v18 offset:12288
    v_mfma_f32_16x16x32_bf16 v[156:159], v[68:71], v[100:103], v[156:159]
    ds_read_b64_tr_b16 v[30:31], v18 offset:13056
    v_mfma_f32_16x16x32_bf16 v[160:163], v[72:75], v[88:91], v[160:163]
    ds_read_b64_tr_b16 v[32:33], v19 offset:0
    v_mfma_f32_16x16x32_bf16 v[168:171], v[72:75], v[92:95], v[168:171]
    ds_read_b64_tr_b16 v[34:35], v19 offset:768
    v_mfma_f32_16x16x32_bf16 v[176:179], v[72:75], v[96:99], v[176:179]
    ds_read_b64_tr_b16 v[36:37], v19 offset:12288
    v_mfma_f32_16x16x32_bf16 v[184:187], v[72:75], v[100:103], v[184:187]
    ds_read_b64_tr_b16 v[38:39], v19 offset:13056
    v_mfma_f32_16x16x32_bf16 v[164:167], v[76:79], v[88:91], v[164:167]
    ds_read_b64_tr_b16 v[40:41], v20 offset:0
    v_mfma_f32_16x16x32_bf16 v[172:175], v[76:79], v[92:95], v[172:175]
    ds_read_b64_tr_b16 v[42:43], v20 offset:768
    v_mfma_f32_16x16x32_bf16 v[180:183], v[76:79], v[96:99], v[180:183]
    ds_read_b64_tr_b16 v[44:45], v20 offset:12288
    v_mfma_f32_16x16x32_bf16 v[188:191], v[76:79], v[100:103], v[188:191]
    ds_read_b64_tr_b16 v[46:47], v20 offset:13056
    v_mfma_f32_16x16x32_bf16 v[192:195], v[80:83], v[88:91], v[192:195]
    v_mfma_f32_16x16x32_bf16 v[200:203], v[80:83], v[92:95], v[200:203]
    v_mfma_f32_16x16x32_bf16 v[208:211], v[80:83], v[96:99], v[208:211]
    v_mfma_f32_16x16x32_bf16 v[216:219], v[80:83], v[100:103], v[216:219]
    v_mfma_f32_16x16x32_bf16 v[196:199], v[84:87], v[88:91], v[196:199]
    v_mfma_f32_16x16x32_bf16 v[204:207], v[84:87], v[92:95], v[204:207]
    v_mfma_f32_16x16x32_bf16 v[212:215], v[84:87], v[96:99], v[212:215]
    v_mfma_f32_16x16x32_bf16 v[220:223], v[84:87], v[100:103], v[220:223]
    s_branch L_cl_standa
L_hook_standa:
    s_cmp_eq_u32 s40, 9
    s_cbranch_scc1 L_clast_standa
    s_cmp_lg_u32 s40, 1
    s_cbranch_scc1 L_hook2_standa
    s_waitcnt vmcnt(0) lgkmcnt(0)
    s_barrier
    ds_read_b64_tr_b16 v[224:225], v14 offset:0
    ds_read_b64_tr_b16 v[226:227], v14 offset:512
    ds_read_b64_tr_b16 v[228:229], v14 offset:4096
    ds_read_b64_tr_b16 v[230:231], v14 offset:4608
    s_branch L_hookr_standa
L_hook2_standa:
    s_cmp_lg_u32 s40, 2
    s_cbranch_scc1 L_hook4_standa
    s_waitcnt lgkmcnt(0)
    s_barrier
    buffer_store_dwordx4 v[224:227], v15, s[24:27], s54 offen sc1
    buffer_store_dwordx4 v[228:231], v15, s[24:27], s55 offen sc1
    s_cmp_lg_u32 s19, 3
    s_cbranch_scc1 L_hookr_standa
    s_mov_b64 exec, 1
    global_load_dwordx2 v[12:13], v10, s[14:15] sc1
    s_mov_b64 exec, -1
    s_branch L_hookr_standa
L_hook4_standa:
    s_cmp_lg_u32 s19, 3
    s_cbranch_scc1 L_hook4b_standa
    s_mov_b64 exec, 1
    s_mov_b32 s45, 0
L_cn_standa:
    s_waitcnt vmcnt(0)
    v_cmp_ne_u32 vcc, 0, v13
    s_cbranch_vccnz L_cn2_standa
    s_add_u32 s45, s45, 1
    s_cmp_ge_u32 s45, 0x80000
    s_cbranch_scc1 L_cn2_standa
    global_load_dwordx2 v[12:13], v10, s[14:15] sc1
    s_branch L_cn_standa
L_cn2_standa:
    ds_write_b64 v9, v[12:13]
    s_waitcnt lgkmcnt(0)
    s_barrier
    global_store_dwordx2 v10, v[12:13], s[58:59] sc1
    s_mov_b64 exec, -1
    s_branch L_hookr_standa
L_hook4b_standa:
    s_waitcnt vmcnt(0) lgkmcnt(0)
    s_barrier
    ds_read_b64 v[12:13], v9
    s_branch L_hookr_standa
L_clast_standa:
    s_waitcnt lgkmcnt(0)
    v_mfma_f32_16x16x32_bf16 v[128:131], v[64:67], v[88:91], v[128:131]
    v_mfma_f32_16x16x32_bf16 v[136:139], v[64:67], v[92:95], v[136:139]
    v_mfma_f32_16x16x32_bf16 v[144:147], v[64:67], v[96:99], v[144:147]
    v_mfma_f32_16x16x32_bf16 v[152:155], v[64:67], v[100:103], v[152:155]
    v_mfma_f32_16x16x32_bf16 v[132:135], v[68:71], v[88:91], v[132:135]
    v_mfma_f32_16x16x32_bf16 v[140:143], v[68:71], v[92:95], v[140:143]
    v_mfma_f32_16x16x32_bf16 v[148:151], v[68:71], v[96:99], v[148:151]
    v_mfma_f32_16x16x32_bf16 v[156:159], v[68:71], v[100:103], v[156:159]
    v_mfma_f32_16x16x32_bf16 v[160:163], v[72:75], v[88:91], v[160:163]
    v_mfma_f32_16x16x32_bf16 v[168:171], v[72:75], v[92:95], v[168:171]
    v_mfma_f32_16x16x32_bf16 v[176:179], v[72:75], v[96:99], v[176:179]
    v_mfma_f32_16x16x32_bf16 v[184:187], v[72:75], v[100:103], v[184:187]
    v_mfma_f32_16x16x32_bf16 v[164:167], v[76:79], v[88:91], v[164:167]
    v_mfma_f32_16x16x32_bf16 v[172:175], v[76:79], v[92:95], v[172:175]
    v_mfma_f32_16x16x32_bf16 v[180:183], v[76:79], v[96:99], v[180:183]
    v_mfma_f32_16x16x32_bf16 v[188:191], v[76:79], v[100:103], v[188:191]
    s_barrier
    v_mfma_f32_16x16x32_bf16 v[192:195], v[80:83], v[88:91], v[192:195]
    ds_read_b128 v[48:51], v16 offset:0
    ds_read_b128 v[52:55], v16 offset:2048
    v_mfma_f32_16x16x32_bf16 v[200:203], v[80:83], v[92:95], v[200:203]
    ds_read_b128 v[56:59], v16 offset:4096
    ds_read_b128 v[60:63], v16 offset:6144
    v_mfma_f32_16x16x32_bf16 v[208:211], v[80:83], v[96:99], v[208:211]
    ds_read_b64_tr_b16 v[24:25], v18 offset:0
    ds_read_b64_tr_b16 v[26:27], v18 offset:768
    v_mfma_f32_16x16x32_bf16 v[216:219], v[80:83], v[100:103], v[216:219]
    ds_read_b64_tr_b16 v[28:29], v18 offset:12288
    ds_read_b64_tr_b16 v[30:31], v18 offset:13056
    v_mfma_f32_16x16x32_bf16 v[196:199], v[84:87], v[88:91], v[196:199]
    ds_read_b128 v[104:107], v17 offset:0
    ds_read_b128 v[108:111], v17 offset:2048
    v_mfma_f32_16x16x32_bf16 v[204:207], v[84:87], v[92:95], v[204:207]
    ds_read_b128 v[112:115], v17 offset:4096
    ds_read_b128 v[116:119], v17 offset:6144
    v_mfma_f32_16x16x32_bf16 v[212:215], v[84:87], v[96:99], v[212:215]
    ds_read_b64_tr_b16 v[224:225], v18 offset:6144
    ds_read_b64_tr_b16 v[226:227], v18 offset:6912
    v_mfma_f32_16x16x32_bf16 v[220:223], v[84:87], v[100:103], v[220:223]
    ds_read_b64_tr_b16 v[228:229], v18 offset:18432
    ds_read_b64_tr_b16 v[230:231], v18 offset:19200
    s_waitcnt lgkmcnt(0)
    v_mfma_f32_16x16x32_bf16 v[128:131], v[24:27], v[48:51], v[128:131]
    ds_read_b64_tr_b16 v[32:33], v19 offset:0
    v_mfma_f32_16x16x32_bf16 v[136:139], v[24:27], v[52:55], v[136:139]
    ds_read_b64_tr_b16 v[34:35], v19 offset:768
    v_mfma_f32_16x16x32_bf16 v[132:135], v[28:31], v[48:51], v[132:135]
    ds_read_b64_tr_b16 v[36:37], v19 offset:12288
    v_mfma_f32_16x16x32_bf16 v[140:143], v[28:31], v[52:55], v[140:143]
    ds_read_b64_tr_b16 v[38:39], v19 offset:13056
    v_mfma_f32_16x16x32_bf16 v[128:131], v[224:227], v[104:107], v[128:131]
    ds_read_b64_tr_b16 v[232:233], v19 offset:6144
    v_mfma_f32_16x16x32_bf16 v[136:139], v[224:227], v[108:111], v[136:139]
    ds_read_b64_tr_b16 v[234:235], v19 offset:6912
    v_mfma_f32_16x16x32_bf16 v[132:135], v[228:231], v[104:107], v[132:135]
    ds_read_b64_tr_b16 v[236:237], v19 offset:18432
    v_mfma_f32_16x16x32_bf16 v[140:143], v[228:231], v[108:111], v[140:143]
    ds_read_b64_tr_b16 v[238:239], v19 offset:19200
    v_mfma_f32_16x16x32_bf16 v[144:147], v[24:27], v[56:59], v[144:147]
    ds_read_b64_tr_b16 v[40:41], v20 offset:0
    v_mfma_f32_16x16x32_bf16 v[152:155], v[24:27], v[60:63], v[152:155]
    ds_read_b64_tr_b16 v[42:43], v20 offset:768
    v_mfma_f32_16x16x32_bf16 v[148:151], v[28:31], v[56:59], v[148:151]
    ds_read_b64_tr_b16 v[44:45], v20 offset:12288
    v_mfma_f32_16x16x32_bf16 v[156:159], v[28:31], v[60:63], v[156:159]
    ds_read_b64_tr_b16 v[46:47], v20 offset:13056
    v_mfma_f32_16x16x32_bf16 v[144:147], v[224:227], v[112:115], v[144:147]
    ds_read_b64_tr_b16 v[240:241], v20 offset:6144
    v_mfma_f32_16x16x32_bf16 v[152:155], v[224:227], v[116:119], v[152:155]
    ds_read_b64_tr_b16 v[242:243], v20 offset:6912
    v_mfma_f32_16x16x32_bf16 v[148:151], v[228:231], v[112:115], v[148:151]
    ds_read_b64_tr_b16 v[244:245], v20 offset:18432
    v_mfma_f32_16x16x32_bf16 v[156:159], v[228:231], v[116:119], v[156:159]
    ds_read_b64_tr_b16 v[246:247], v20 offset:19200
    s_waitcnt lgkmcnt(0)
    s_barrier
    v_mfma_f32_16x16x32_bf16 v[160:163], v[32:35], v[48:51], v[160:163]
    v_mul_f32 v128, s44, v128
    v_mul_f32 v129, s44, v129
    v_mfma_f32_16x16x32_bf16 v[168:171], v[32:35], v[52:55], v[168:171]
    v_mul_f32 v130, s44, v130
    v_mul_f32 v131, s44, v131
    v_mfma_f32_16x16x32_bf16 v[164:167], v[36:39], v[48:51], v[164:167]
    v_mul_f32 v136, s44, v136
    v_mul_f32 v137, s44, v137
    v_mfma_f32_16x16x32_bf16 v[172:175], v[36:39], v[52:55], v[172:175]
    v_mul_f32 v138, s44, v138
    v_mul_f32 v139, s44, v139
    v_mfma_f32_16x16x32_bf16 v[160:163], v[232:235], v[104:107], v[160:163]
    v_exp_f32 v128, v128
    v_exp_f32 v129, v129
    v_mfma_f32_16x16x32_bf16 v[168:171], v[232:235], v[108:111], v[168:171]
    v_exp_f32 v130, v130
    v_exp_f32 v131, v131
    v_mfma_f32_16x16x32_bf16 v[164:167], v[236:239], v[104:107], v[164:167]
    v_exp_f32 v136, v136
    v_exp_f32 v137, v137
    v_mfma_f32_16x16x32_bf16 v[172:175], v[236:239], v[108:111], v[172:175]
    v_exp_f32 v138, v138
    v_exp_f32 v139, v139
    v_mfma_f32_16x16x32_bf16 v[176:179], v[32:35], v[56:59], v[176:179]
    v_add_f32 v128, 1.0, v128
    v_add_f32 v129, 1.0, v129
    v_mfma_f32_16x16x32_bf16 v[184:187], v[32:35], v[60:63], v[184:187]
    v_add_f32 v130, 1.0, v130
    v_add_f32 v131, 1.0, v131
    v_mfma_f32_16x16x32_bf16 v[180:183], v[36:39], v[56:59], v[180:183]
    v_add_f32 v136, 1.0, v136
    v_add_f32 v137, 1.0, v137
    v_mfma_f32_16x16x32_bf16 v[188:191], v[36:39], v[60:63], v[188:191]
    v_add_f32 v138, 1.0, v138
    v_add_f32 v139, 1.0, v139
    v_mfma_f32_16x16x32_bf16 v[176:179], v[232:235], v[112:115], v[176:179]
    v_rcp_f32 v128, v128
    v_rcp_f32 v129, v129
    v_mfma_f32_16x16x32_bf16 v[184:187], v[232:235], v[116:119], v[184:187]
    v_rcp_f32 v130, v130
    v_rcp_f32 v131, v131
    v_mfma_f32_16x16x32_bf16 v[180:183], v[236:239], v[112:115], v[180:183]
    v_rcp_f32 v136, v136
    v_rcp_f32 v137, v137
    v_mfma_f32_16x16x32_bf16 v[188:191], v[236:239], v[116:119], v[188:191]
    v_rcp_f32 v138, v138
    v_rcp_f32 v139, v139
    v_mfma_f32_16x16x32_bf16 v[192:195], v[40:43], v[48:51], v[192:195]
    v_mul_f32 v128, v128, v132
    v_mul_f32 v129, v129, v133
    v_mfma_f32_16x16x32_bf16 v[200:203], v[40:43], v[52:55], v[200:203]
    v_mul_f32 v130, v130, v134
    v_mul_f32 v131, v131, v135
    v_mfma_f32_16x16x32_bf16 v[196:199], v[44:47], v[48:51], v[196:199]
    v_mul_f32 v136, v136, v140
    v_mul_f32 v137, v137, v141
    v_mfma_f32_16x16x32_bf16 v[204:207], v[44:47], v[52:55], v[204:207]
    v_mul_f32 v138, v138, v142
    v_mul_f32 v139, v139, v143
    v_mfma_f32_16x16x32_bf16 v[192:195], v[240:243], v[104:107], v[192:195]
    v_cvt_pk_bf16_f32 v132, v128, v129
    v_cvt_pk_bf16_f32 v133, v130, v131
    v_mfma_f32_16x16x32_bf16 v[200:203], v[240:243], v[108:111], v[200:203]
    v_cvt_pk_bf16_f32 v134, v136, v137
    v_cvt_pk_bf16_f32 v135, v138, v139
    v_mfma_f32_16x16x32_bf16 v[196:199], v[244:247], v[104:107], v[196:199]
    s_nop 1
    v_permlane16_swap_b32 v132, v134
    v_mfma_f32_16x16x32_bf16 v[204:207], v[244:247], v[108:111], v[204:207]
    v_permlane16_swap_b32 v133, v135
    buffer_store_dwordx4 v[132:135], v8, s[28:31], s64 offen offset:0 sc1
    v_mfma_f32_16x16x32_bf16 v[208:211], v[40:43], v[56:59], v[208:211]
    v_mul_f32 v144, s44, v144
    v_mul_f32 v145, s44, v145
    v_mfma_f32_16x16x32_bf16 v[216:219], v[40:43], v[60:63], v[216:219]
    v_mul_f32 v146, s44, v146
    v_mul_f32 v147, s44, v147
    v_mfma_f32_16x16x32_bf16 v[212:215], v[44:47], v[56:59], v[212:215]
    v_mul_f32 v152, s44, v152
    v_mul_f32 v153, s44, v153
    v_mfma_f32_16x16x32_bf16 v[220:223], v[44:47], v[60:63], v[220:223]
    v_mul_f32 v154, s44, v154
    v_mul_f32 v155, s44, v155
    v_mfma_f32_16x16x32_bf16 v[208:211], v[240:243], v[112:115], v[208:211]
    v_exp_f32 v144, v144
    v_exp_f32 v145, v145
    v_mfma_f32_16x16x32_bf16 v[216:219], v[240:243], v[116:119], v[216:219]
    v_exp_f32 v146, v146
    v_exp_f32 v147, v147
    v_mfma_f32_16x16x32_bf16 v[212:215], v[244:247], v[112:115], v[212:215]
    v_exp_f32 v152, v152
    v_exp_f32 v153, v153
    v_mfma_f32_16x16x32_bf16 v[220:223], v[244:247], v[116:119], v[220:223]
    v_exp_f32 v154, v154
    v_exp_f32 v155, v155
    v_add_f32 v144, 1.0, v144
    v_add_f32 v145, 1.0, v145
    v_add_f32 v146, 1.0, v146
    v_add_f32 v147, 1.0, v147
    v_add_f32 v152, 1.0, v152
    v_add_f32 v153, 1.0, v153
    v_add_f32 v154, 1.0, v154
    v_add_f32 v155, 1.0, v155
    v_rcp_f32 v144, v144
    v_rcp_f32 v145, v145
    v_rcp_f32 v146, v146
    v_rcp_f32 v147, v147
    v_rcp_f32 v152, v152
    v_rcp_f32 v153, v153
    v_rcp_f32 v154, v154
    v_rcp_f32 v155, v155
    v_mul_f32 v144, v144, v148
    v_mul_f32 v145, v145, v149
    v_mul_f32 v146, v146, v150
    v_mul_f32 v147, v147, v151
    v_mul_f32 v152, v152, v156
    v_mul_f32 v153, v153, v157
    v_mul_f32 v154, v154, v158
    v_mul_f32 v155, v155, v159
    v_cvt_pk_bf16_f32 v148, v144, v145
    v_cvt_pk_bf16_f32 v149, v146, v147
    v_cvt_pk_bf16_f32 v150, v152, v153
    v_cvt_pk_bf16_f32 v151, v154, v155
    s_nop 1
    v_permlane16_swap_b32 v148, v150
    v_permlane16_swap_b32 v149, v151
    buffer_store_dwordx4 v[148:151], v8, s[28:31], s64 offen offset:2048 sc1
    v_mul_f32 v160, s44, v160
    v_mul_f32 v161, s44, v161
    v_mul_f32 v162, s44, v162
    v_mul_f32 v163, s44, v163
    v_mul_f32 v168, s44, v168
    v_mul_f32 v169, s44, v169
    v_mul_f32 v170, s44, v170
    v_mul_f32 v171, s44, v171
    v_exp_f32 v160, v160
    v_exp_f32 v161, v161
    v_exp_f32 v162, v162
    v_exp_f32 v163, v163
    v_exp_f32 v168, v168
    v_exp_f32 v169, v169
    v_exp_f32 v170, v170
    v_exp_f32 v171, v171
    v_add_f32 v160, 1.0, v160
    v_add_f32 v161, 1.0, v161
    v_add_f32 v162, 1.0, v162
    v_add_f32 v163, 1.0, v163
    v_add_f32 v168, 1.0, v168
    v_add_f32 v169, 1.0, v169
    v_add_f32 v170, 1.0, v170
    v_add_f32 v171, 1.0, v171
    v_rcp_f32 v160, v160
    v_rcp_f32 v161, v161
    v_rcp_f32 v162, v162
    v_rcp_f32 v163, v163
    v_rcp_f32 v168, v168
    v_rcp_f32 v169, v169
    v_rcp_f32 v170, v170
    v_rcp_f32 v171, v171
    v_mul_f32 v160, v160, v164
    v_mul_f32 v161, v161, v165
    v_mul_f32 v162, v162, v166
    v_mul_f32 v163, v163, v167
    v_mul_f32 v168, v168, v172
    v_mul_f32 v169, v169, v173
    v_mul_f32 v170, v170, v174
    v_mul_f32 v171, v171, v175
    v_cvt_pk_bf16_f32 v164, v160, v161
    v_cvt_pk_bf16_f32 v165, v162, v163
    v_cvt_pk_bf16_f32 v166, v168, v169
    v_cvt_pk_bf16_f32 v167, v170, v171
    s_nop 1
    v_permlane16_swap_b32 v164, v166
    v_permlane16_swap_b32 v165, v167
    buffer_store_dwordx4 v[164:167], v8, s[28:31], s65 offen offset:0 sc1
    v_mul_f32 v176, s44, v176
    v_mul_f32 v177, s44, v177
    v_mul_f32 v178, s44, v178
    v_mul_f32 v179, s44, v179
    v_mul_f32 v184, s44, v184
    v_mul_f32 v185, s44, v185
    v_mul_f32 v186, s44, v186
    v_mul_f32 v187, s44, v187
    v_exp_f32 v176, v176
    v_exp_f32 v177, v177
    v_exp_f32 v178, v178
    v_exp_f32 v179, v179
    v_exp_f32 v184, v184
    v_exp_f32 v185, v185
    v_exp_f32 v186, v186
    v_exp_f32 v187, v187
    v_add_f32 v176, 1.0, v176
    v_add_f32 v177, 1.0, v177
    v_add_f32 v178, 1.0, v178
    v_add_f32 v179, 1.0, v179
    v_add_f32 v184, 1.0, v184
    v_add_f32 v185, 1.0, v185
    v_add_f32 v186, 1.0, v186
    v_add_f32 v187, 1.0, v187
    v_rcp_f32 v176, v176
    v_rcp_f32 v177, v177
    v_rcp_f32 v178, v178
    v_rcp_f32 v179, v179
    v_rcp_f32 v184, v184
    v_rcp_f32 v185, v185
    v_rcp_f32 v186, v186
    v_rcp_f32 v187, v187
    v_mul_f32 v176, v176, v180
    v_mul_f32 v177, v177, v181
    v_mul_f32 v178, v178, v182
    v_mul_f32 v179, v179, v183
    v_mul_f32 v184, v184, v188
    v_mul_f32 v185, v185, v189
    v_mul_f32 v186, v186, v190
    v_mul_f32 v187, v187, v191
    v_cvt_pk_bf16_f32 v180, v176, v177
    v_cvt_pk_bf16_f32 v181, v178, v179
    v_cvt_pk_bf16_f32 v182, v184, v185
    v_cvt_pk_bf16_f32 v183, v186, v187
    s_nop 1
    v_permlane16_swap_b32 v180, v182
    v_permlane16_swap_b32 v181, v183
    buffer_store_dwordx4 v[180:183], v8, s[28:31], s65 offen offset:2048 sc1
    v_mul_f32 v192, s44, v192
    v_mul_f32 v193, s44, v193
    v_mul_f32 v194, s44, v194
    v_mul_f32 v195, s44, v195
    v_mul_f32 v200, s44, v200
    v_mul_f32 v201, s44, v201
    v_mul_f32 v202, s44, v202
    v_mul_f32 v203, s44, v203
    v_exp_f32 v192, v192
    v_exp_f32 v193, v193
    v_exp_f32 v194, v194
    v_exp_f32 v195, v195
    v_exp_f32 v200, v200
    v_exp_f32 v201, v201
    v_exp_f32 v202, v202
    v_exp_f32 v203, v203
    v_add_f32 v192, 1.0, v192
    v_add_f32 v193, 1.0, v193
    v_add_f32 v194, 1.0, v194
    v_add_f32 v195, 1.0, v195
    v_add_f32 v200, 1.0, v200
    v_add_f32 v201, 1.0, v201
    v_add_f32 v202, 1.0, v202
    v_add_f32 v203, 1.0, v203
    v_rcp_f32 v192, v192
    v_rcp_f32 v193, v193
    v_rcp_f32 v194, v194
    v_rcp_f32 v195, v195
    v_rcp_f32 v200, v200
    v_rcp_f32 v201, v201
    v_rcp_f32 v202, v202
    v_rcp_f32 v203, v203
    v_mul_f32 v192, v192, v196
    v_mul_f32 v193, v193, v197
    v_mul_f32 v194, v194, v198
    v_mul_f32 v195, v195, v199
    v_mul_f32 v200, v200, v204
    v_mul_f32 v201, v201, v205
    v_mul_f32 v202, v202, v206
    v_mul_f32 v203, v203, v207
    v_cvt_pk_bf16_f32 v196, v192, v193
    v_cvt_pk_bf16_f32 v197, v194, v195
    v_cvt_pk_bf16_f32 v198, v200, v201
    v_cvt_pk_bf16_f32 v199, v202, v203
    s_nop 1
    v_permlane16_swap_b32 v196, v198
    v_permlane16_swap_b32 v197, v199
    buffer_store_dwordx4 v[196:199], v8, s[28:31], s66 offen offset:0 sc1
    v_mul_f32 v208, s44, v208
    v_mul_f32 v209, s44, v209
    v_mul_f32 v210, s44, v210
    v_mul_f32 v211, s44, v211
    v_mul_f32 v216, s44, v216
    v_mul_f32 v217, s44, v217
    v_mul_f32 v218, s44, v218
    v_mul_f32 v219, s44, v219
    v_exp_f32 v208, v208
    v_exp_f32 v209, v209
    v_exp_f32 v210, v210
    v_exp_f32 v211, v211
    v_exp_f32 v216, v216
    v_exp_f32 v217, v217
    v_exp_f32 v218, v218
    v_exp_f32 v219, v219
    v_add_f32 v208, 1.0, v208
    v_add_f32 v209, 1.0, v209
    v_add_f32 v210, 1.0, v210
    v_add_f32 v211, 1.0, v211
    v_add_f32 v216, 1.0, v216
    v_add_f32 v217, 1.0, v217
    v_add_f32 v218, 1.0, v218
    v_add_f32 v219, 1.0, v219
    v_rcp_f32 v208, v208
    v_rcp_f32 v209, v209
    v_rcp_f32 v210, v210
    v_rcp_f32 v211, v211
    v_rcp_f32 v216, v216
    v_rcp_f32 v217, v217
    v_rcp_f32 v218, v218
    v_rcp_f32 v219, v219
    v_mul_f32 v208, v208, v212
    v_mul_f32 v209, v209, v213
    v_mul_f32 v210, v210, v214
    v_mul_f32 v211, v211, v215
    v_mul_f32 v216, v216, v220
    v_mul_f32 v217, v217, v221
    v_mul_f32 v218, v218, v222
    v_mul_f32 v219, v219, v223
    v_cvt_pk_bf16_f32 v212, v208, v209
    v_cvt_pk_bf16_f32 v213, v210, v211
    v_cvt_pk_bf16_f32 v214, v216, v217
    v_cvt_pk_bf16_f32 v215, v218, v219
    s_nop 1
    v_permlane16_swap_b32 v212, v214
    v_permlane16_swap_b32 v213, v215
    buffer_store_dwordx4 v[212:215], v8, s[28:31], s66 offen offset:2048 sc1
    s_barrier
    s_waitcnt vmcnt(0)
    s_mov_b64 exec, 1
    global_store_dwordx2 v10, v[12:13], s[62:63] sc1
L_end_standa:
    s_endpgm

.section .rodata,"a"
.p2align 6
.amdhsa_kernel standalone__glu_gated_glu__prompt_kernel
  .amdhsa_next_free_vgpr 248
  .amdhsa_next_free_sgpr 102
  .amdhsa_accum_offset 248
  .amdhsa_group_segment_fixed_size 0
  .amdhsa_kernarg_size 56
  .amdhsa_user_sgpr_count 2
  .amdhsa_user_sgpr_kernarg_segment_ptr 1
  .amdhsa_system_sgpr_workgroup_id_x 1
.end_amdhsa_kernel
```
